```python
import torch

def _softmax(x, axis=-1):
    return torch.softmax(x, dim=axis)
def _gelu(x):
    return torch.nn.functional.gelu(x, approximate="tanh")
def _silu(x):
    return torch.nn.functional.silu(x)
def _sigmoid(x):
    return torch.sigmoid(x)
def _layernorm(x, axis=-1, eps=1e-5):
    m = x.mean(dim=axis, keepdim=True)
    v = x.var(dim=axis, keepdim=True, unbiased=False)
    return (x - m) / torch.sqrt(v + eps)
def _scatter_add(tgt, idx, src, axis=0):
    return tgt.clone().index_add_(axis, idx, src)
def _segment_sum(src, seg, n):
    out = torch.zeros((n,) + src.shape[1:], dtype=src.dtype)
    return out.index_add_(0, seg, src)
def _pad(x, pw):
    flat = tuple(v for pair in reversed(pw) for v in pair)
    return torch.nn.functional.pad(x, flat)

kernel_name = 'parallel_sum__mha_block_cached__swiglu_ffn__decode'

def setup_inputs():

    _w = (lambda a: (lambda t: t.to(torch.bfloat16) if t.is_floating_point() else t)(torch.as_tensor(a)))
    def _A_setup():
        B, Sq, D = 2, 1, 640
        H, Sk, Dh = 32, 4096, 192
        return {
            "x": _w((lambda *s: torch.randn(*s, dtype=torch.bfloat16) * 0.05)(B, Sq, D)),
            "k_cache": _w((lambda *s: torch.randn(*s, dtype=torch.bfloat16) * 3.2)(B, H, Sk, Dh)),
            "v_cache": _w((lambda *s: torch.randn(*s, dtype=torch.bfloat16) * 1.6)(B, H, Sk, Dh)),
            "wq": _w((lambda *s: torch.randn(*s, dtype=torch.bfloat16) * 3.2)(D, H * Dh) * (D ** -0.5)),
            "wo": _w((lambda *s: torch.randn(*s, dtype=torch.bfloat16) * 1.6)(H * Dh, D) * ((H * Dh) ** -0.5)),
        }
    _A_in = _A_setup()

    def _B_setup():
        B, S, D, F = 2, 1, 640, 1536
        return {
            "x": _w((lambda *s: torch.randn(*s, dtype=torch.bfloat16) * 0.05)(B, S, D)),
            "w_gate": _w((lambda *s: torch.randn(*s, dtype=torch.bfloat16) * 0.05)(D, F)),
            "w_up": _w((lambda *s: torch.randn(*s, dtype=torch.bfloat16) * 0.05)(D, F)),
            "w_down": _w((lambda *s: torch.randn(*s, dtype=torch.bfloat16) * 0.05)(F, D)),
        }
    _B_in = _B_setup()

    return {
        "A_x": _A_in["x"],
        "A_k_cache": _A_in["k_cache"],
        "A_v_cache": _A_in["v_cache"],
        "A_wq": _A_in["wq"],
        "A_wo": _A_in["wo"],
        "B_x": _B_in["x"],
        "B_w_gate": _B_in["w_gate"],
        "B_w_up": _B_in["w_up"],
        "B_w_down": _B_in["w_down"],
    }

def reference(A_x, A_k_cache, A_v_cache, A_wq, A_wo, B_x, B_w_gate, B_w_up, B_w_down):
    def _A_ref(x, k_cache, v_cache, wq, wo):
        B, Sq, D = x.shape
        H, Dh = 32, 192
        q = (lambda x, *d: x.permute(*d))((x @ wq).reshape(B, Sq, H, Dh), 0, 2, 1, 3)
        scores = torch.einsum("bhqd,bhkd->bhqk", q, k_cache) * (Dh ** -0.5)
        p = _softmax(scores, axis=-1)
        o = torch.einsum("bhqk,bhkd->bhqd", p, v_cache)
        return (lambda x, *d: x.permute(*d))(o, 0, 2, 1, 3).reshape(B, Sq, H * Dh) @ wo

    def _B_ref(x, w_gate, w_up, w_down):
        g = _silu(x @ w_gate)
        u = x @ w_up
        return (g * u) @ w_down

    x = A_x
    xn = _layernorm(x, axis=-1)
    return x + _A_ref(xn, A_k_cache, A_v_cache, A_wq, A_wo) + _B_ref(xn, B_w_gate, B_w_up, B_w_down)
```

```asm
; @launch grid=(256,1,1) block=(512,1,1) lds=95232
.amdgcn_target "amdgcn-amd-amdhsa--gfx950"
.text
.globl parallel_sum__mha_block_cached__swiglu_ffn__decode_kernel
.p2align 8
.type parallel_sum__mha_block_cached__swiglu_ffn__decode_kernel,@function
parallel_sum__mha_block_cached__swiglu_ffn__decode_kernel:
  s_cmp_ge_u32 s2, 256
  s_cbranch_scc1 L_exit
  s_load_dwordx16 s[4:19], s[0:1], 0
  s_load_dwordx8 s[20:27], s[0:1], 64
  v_lshrrev_b32 v1, 6, v0
  v_and_b32 v0, 63, v0
  s_and_b32 s29, s2, 7
  v_readfirstlane_b32 s28, v1
  s_lshr_b32 s34, s2, 3
  s_lshr_b32 s30, s34, 3
  s_and_b32 s31, s34, 7
  s_lshl_b32 s35, s29, 2
  s_add_u32 s35, s35, s30
  s_lshr_b32 s32, s31, 2
  s_and_b32 s33, s31, 3
  s_lshl_b32 s56, s32, 5
  s_add_u32 s56, s56, s35
  s_lshl_b32 s56, s56, 12
  s_lshl_b32 s57, s33, 10
  s_add_u32 s56, s56, s57
  s_lshl_b32 s57, s28, 8
  s_add_u32 s56, s56, s57
  s_mul_i32 s58, s56, 384
  v_lshrrev_b32 v48, 3, v0
  v_mul_u32_u24 v48, 384, v48
  v_and_b32 v49, 7, v0
  v_lshlrev_b32 v50, 4, v49
  v_add_u32 v1, v48, v50
  s_waitcnt lgkmcnt(0)
  s_load_dwordx2 s[36:37], s[26:27], 0
  s_mov_b32 s52, s26
  s_and_b32 s53, s27, 0xffff
  s_mov_b32 s54, 8388608
  s_mov_b32 s55, 0x20000
  s_cmp_ge_u32 s28, 4
  s_cbranch_scc1 L_aux
  s_mov_b32 s40, s6
  s_and_b32 s41, s7, 0xffff
  s_mov_b32 s42, 100663296
  s_mov_b32 s43, 0x20000
  s_mov_b32 s59, s58
  buffer_load_dwordx4 v[72:75], v1, s[40:43], s59 offen offset:0 nt
  buffer_load_dwordx4 v[76:79], v1, s[40:43], s59 offen offset:128 nt
  buffer_load_dwordx4 v[80:83], v1, s[40:43], s59 offen offset:256 nt
  buffer_load_dwordx4 v[84:87], v1, s[40:43], s59 offen offset:3072 nt
  s_barrier
  buffer_load_dwordx4 v[88:91], v1, s[40:43], s59 offen offset:3200 nt
  s_waitcnt vmcnt(4)
  buffer_load_dwordx4 v[92:95], v1, s[40:43], s59 offen offset:3328 nt
  s_mov_b32 s44, s8
  s_and_b32 s45, s9, 0xffff
  s_mov_b32 s46, 100663296
  s_mov_b32 s47, 0x20000
  v_lshrrev_b32 v243, 5, v0
  s_lshl_b32 s63, s28, 1
  v_add_u32 v243, s63, v243
  v_mul_u32_u24 v243, 768, v243
  v_and_b32 v49, 7, v0
  v_lshlrev_b32 v49, 5, v49
  v_and_b32 v50, 16, v0
  s_add_u32 s59, s59, 6144
  s_waitcnt vmcnt(4)
  buffer_load_dwordx4 v[96:99], v1, s[40:43], s59 offen offset:0 nt
  v_add3_u32 v243, v243, v49, v50
  s_lshl_b32 s63, s28, 2
  v_mov_b32 v244, s63
  v_and_b32 v49, 7, v0
  v_and_b32 v50, 1, v0
  v_mov_b32 v51, 0xffff
  v_mov_b32 v52, 0xffff0000
  v_cmp_eq_u32 vcc, 1, v50
  v_lshrrev_b32 v49, 1, v49
  s_nop 0
  v_cndmask_b32 v51, v51, v52, vcc
  s_waitcnt vmcnt(4)
  buffer_load_dwordx4 v[100:103], v1, s[40:43], s59 offen offset:128 nt
  v_cmp_eq_u32 vcc, 0, v49
  s_nop 1
  v_cndmask_b32 v2, 0, v51, vcc
  v_cmp_eq_u32 vcc, 1, v49
  s_nop 1
  v_cndmask_b32 v3, 0, v51, vcc
  v_cmp_eq_u32 vcc, 2, v49
  s_nop 1
  v_cndmask_b32 v4, 0, v51, vcc
  v_cmp_eq_u32 vcc, 3, v49
  s_nop 1
  s_waitcnt vmcnt(4)
  buffer_load_dwordx4 v[104:107], v1, s[40:43], s59 offen offset:256 nt
  v_cndmask_b32 v5, 0, v51, vcc
  v_mov_b32 v20, 0
  v_mov_b32 v21, 0
  v_mov_b32 v22, 0
  v_mov_b32 v23, 0
  v_mov_b32 v24, 0
  v_mov_b32 v25, 0
  v_mov_b32 v26, 0
  v_mov_b32 v27, 0
  v_mov_b32 v28, 0
  v_mov_b32 v29, 0
  s_waitcnt vmcnt(4)
  buffer_load_dwordx4 v[108:111], v1, s[40:43], s59 offen offset:3072 nt
  v_mov_b32 v30, 0
  v_mov_b32 v31, 0
  v_mov_b32 v240, 0
  v_mov_b32 v241, 1
  s_lshl_b32 s64, s28, 6
  v_add_u32 v225, s64, v0
  v_mov_b32 v224, 96
  v_cmp_eq_u32 vcc, v224, v225
  s_mov_b64 s[74:75], vcc
  v_cmp_ge_u32 vcc, v224, v225
  s_waitcnt vmcnt(4)
  buffer_load_dwordx4 v[112:115], v1, s[40:43], s59 offen offset:3200 nt
  s_mov_b64 s[72:73], vcc
  v_min_u32 v224, 95, v225
  v_lshlrev_b32 v224, 3, v224
  v_lshlrev_b32 v225, 4, v225
  s_lshl_b32 s64, s35, 3
  s_add_u32 s64, s64, s31
  s_lshl_b32 s64, s64, 11
  s_add_u32 s64, s64, 1310720
  s_sub_u32 s65, s28, 2
  s_cmp_ge_i32 s65, 3
  s_cselect_b32 s66, 1, 0
  s_waitcnt vmcnt(4)
  buffer_load_dwordx4 v[116:119], v1, s[40:43], s59 offen offset:3328 nt
  s_mul_i32 s67, s66, 3
  s_sub_u32 s67, s65, s67
  v_lshrrev_b32 v227, 5, v0
  v_lshlrev_b32 v227, 11, v227
  v_and_b32 v228, 31, v0
  s_lshl_b32 s68, s67, 5
  v_add_u32 v226, s68, v228
  v_lshl_add_u32 v226, v226, 4, v227
  v_add_u32 v227, 1536, v227
  s_mul_i32 s68, s66, 384
  s_lshl_b32 s69, s67, 7
  s_add_u32 s59, s59, 6144
  s_waitcnt vmcnt(4)
  buffer_load_dwordx4 v[120:123], v1, s[40:43], s59 offen offset:0 nt
  s_add_u32 s68, s68, s69
  s_add_u32 s68, s68, 3200
  v_lshl_add_u32 v228, v228, 2, s68
  s_lshl_b32 s65, s35, 3
  s_lshl_b32 s66, s66, 2
  s_add_u32 s65, s65, s66
  s_lshl_b32 s65, s65, 11
  s_add_u32 s65, s65, 1310720
  s_add_u32 s66, s65, 4096
  v_and_b32 v234, 15, v0
  v_lshrrev_b32 v235, 4, v0
  s_waitcnt vmcnt(4)
  buffer_load_dwordx4 v[124:127], v1, s[40:43], s59 offen offset:128 nt
  v_and_b32 v236, 1, v0
  v_lshlrev_b32 v237, 4, v235
  v_mul_u32_u24 v229, 384, v236
  v_add_u32 v229, v229, v237
  v_add_u32 v229, 3200, v229
  v_lshlrev_b32 v230, 7, v236
  v_add_u32 v230, v230, v237
  v_add_u32 v230, 2944, v230
  v_lshlrev_b32 v231, 3, v235
  v_lshrrev_b32 v232, 2, v234
  v_add_u32 v231, v231, v232
  s_waitcnt vmcnt(4)
  buffer_load_dwordx4 v[128:131], v1, s[40:43], s59 offen offset:256 nt
  v_mul_u32_u24 v231, 160, v231
  v_and_b32 v232, 3, v234
  v_lshlrev_b32 v232, 3, v232
  s_lshl_b32 s67, s28, 5
  v_add3_u32 v231, v231, v232, s67
  v_add_u32 v231, 56320, v231
  v_cmp_le_u32 vcc, 2, v235
  v_subrev_u32 v232, 2560, v231
  s_nop 0
  v_cndmask_b32 v232, v231, v232, vcc
  v_and_b32 v233, 1, v235
  s_waitcnt vmcnt(4)
  buffer_load_dwordx4 v[132:135], v1, s[40:43], s59 offen offset:3072 nt
  v_mul_u32_u24 v233, 40960, v233
  v_lshrrev_b32 v237, 3, v234
  v_lshl_add_u32 v233, v237, 12, v233
  v_and_b32 v237, 7, v234
  v_lshl_add_u32 v233, v237, 4, v233
  v_and_b32 v237, 16, v0
  v_cmp_eq_u32 vcc, 16, v237
  s_mov_b64 s[76:77], vcc
  s_mul_i32 s67, s31, 10
  s_add_u32 s67, s67, s28
  s_lshl_b32 s67, s67, 13
  s_waitcnt vmcnt(4)
  buffer_load_dwordx4 v[136:139], v1, s[40:43], s59 offen offset:3200 nt
  s_lshl_b32 s68, s35, 7
  s_add_u32 s67, s67, s68
  s_add_u32 s67, s67, 1835008
  s_mov_b32 s80, 1048576
  s_mov_b32 s62, 1069066811
  s_waitcnt lgkmcnt(0)
  s_add_u32 s36, s36, 1
  v_mov_b32 v238, s36
  v_mov_b32 v239, s37
  s_waitcnt vmcnt(4)
  buffer_load_dwordx4 v[140:143], v1, s[40:43], s59 offen offset:3328 nt
  s_add_u32 s59, s59, 6144
  s_waitcnt vmcnt(4)
  buffer_load_dwordx4 v[144:147], v1, s[40:43], s59 offen offset:0 nt
  s_waitcnt vmcnt(4)
  buffer_load_dwordx4 v[148:151], v1, s[40:43], s59 offen offset:128 nt
  s_waitcnt vmcnt(4)
  buffer_load_dwordx4 v[152:155], v1, s[40:43], s59 offen offset:256 nt
  s_waitcnt vmcnt(4)
  buffer_load_dwordx4 v[156:159], v1, s[40:43], s59 offen offset:3072 nt
  s_waitcnt vmcnt(4)
  buffer_load_dwordx4 v[160:163], v1, s[40:43], s59 offen offset:3200 nt
  s_waitcnt vmcnt(4)
  buffer_load_dwordx4 v[164:167], v1, s[40:43], s59 offen offset:3328 nt
  s_add_u32 s59, s59, 6144
  s_barrier
  v_and_b32 v48, 7, v0
  v_lshlrev_b32 v48, 4, v48
  ds_read_b128 v[8:11], v48 offset:2560
  ds_read_b128 v[12:15], v48 offset:2688
  ds_read_b128 v[16:19], v48 offset:2816
  ds_read_b32 v57, v240 offset:4052
  v_mov_b32 v56, 0xff800000
  s_mov_b32 s60, 1033096506
  s_mov_b32 s61, 0xffff0000
  s_mov_b32 s62, 1069066811
  s_waitcnt lgkmcnt(0)
  v_readfirstlane_b32 s87, v57
  s_waitcnt vmcnt(18)
  v_mov_b32 v48, 0
  v_mov_b32 v49, 0
  v_dot2c_f32_bf16 v48, v72, v8
  v_dot2c_f32_bf16 v48, v73, v9
  v_dot2c_f32_bf16 v48, v74, v10
  v_dot2c_f32_bf16 v48, v75, v11
  v_dot2c_f32_bf16 v48, v76, v12
  v_dot2c_f32_bf16 v48, v77, v13
  v_dot2c_f32_bf16 v48, v78, v14
  v_dot2c_f32_bf16 v48, v79, v15
  v_dot2c_f32_bf16 v48, v80, v16
  v_dot2c_f32_bf16 v48, v81, v17
  v_dot2c_f32_bf16 v48, v82, v18
  v_dot2c_f32_bf16 v48, v83, v19
  v_dot2c_f32_bf16 v49, v84, v8
  v_dot2c_f32_bf16 v49, v85, v9
  v_dot2c_f32_bf16 v49, v86, v10
  v_dot2c_f32_bf16 v49, v87, v11
  v_dot2c_f32_bf16 v49, v88, v12
  v_dot2c_f32_bf16 v49, v89, v13
  v_dot2c_f32_bf16 v49, v90, v14
  v_dot2c_f32_bf16 v49, v91, v15
  v_dot2c_f32_bf16 v49, v92, v16
  v_dot2c_f32_bf16 v49, v93, v17
  v_dot2c_f32_bf16 v49, v94, v18
  v_dot2c_f32_bf16 v49, v95, v19
  v_add_f32_dpp v48, v48, v48 quad_perm:[1,0,3,2] row_mask:0xf bank_mask:0xf
  s_waitcnt vmcnt(4)
  buffer_load_dwordx4 v[72:75], v1, s[40:43], s59 offen offset:0 nt
  v_add_f32_dpp v49, v49, v49 quad_perm:[1,0,3,2] row_mask:0xf bank_mask:0xf
  v_add_f32_dpp v48, v48, v48 quad_perm:[2,3,0,1] row_mask:0xf bank_mask:0xf
  s_waitcnt vmcnt(4)
  v_add_f32_dpp v49, v49, v49 quad_perm:[2,3,0,1] row_mask:0xf bank_mask:0xf
  v_add_f32_dpp v48, v48, v48 row_half_mirror row_mask:0xf bank_mask:0xf
  buffer_load_dwordx4 v[76:79], v1, s[40:43], s59 offen offset:128 nt
  v_add_f32_dpp v49, v49, v49 row_half_mirror row_mask:0xf bank_mask:0xf
  s_waitcnt vmcnt(4)
  buffer_load_dwordx4 v[80:83], v1, s[40:43], s59 offen offset:256 nt
  s_waitcnt vmcnt(4)
  buffer_load_dwordx4 v[84:87], v1, s[40:43], s59 offen offset:3072 nt
  s_waitcnt vmcnt(4)
  buffer_load_dwordx4 v[88:91], v1, s[40:43], s59 offen offset:3200 nt
  s_waitcnt vmcnt(4)
  buffer_load_dwordx4 v[92:95], v1, s[40:43], s59 offen offset:3328 nt
  s_add_u32 s59, s59, 6144
  v_cvt_pk_bf16_f32 v50, v48, v49
  v_lshlrev_b32 v51, 16, v50
  v_and_b32 v52, s61, v50
  v_mul_f32 v51, s60, v51
  v_mul_f32 v52, s60, v52
  v_max3_f32 v56, v56, v51, v52
  v_cvt_pk_bf16_f32 v32, v51, v52
  s_waitcnt vmcnt(18)
  v_mov_b32 v48, 0
  v_mov_b32 v49, 0
  v_dot2c_f32_bf16 v48, v96, v8
  v_dot2c_f32_bf16 v48, v97, v9
  v_dot2c_f32_bf16 v48, v98, v10
  v_dot2c_f32_bf16 v48, v99, v11
  v_dot2c_f32_bf16 v48, v100, v12
  v_dot2c_f32_bf16 v48, v101, v13
  v_dot2c_f32_bf16 v48, v102, v14
  v_dot2c_f32_bf16 v48, v103, v15
  v_dot2c_f32_bf16 v48, v104, v16
  v_dot2c_f32_bf16 v48, v105, v17
  v_dot2c_f32_bf16 v48, v106, v18
  v_dot2c_f32_bf16 v48, v107, v19
  v_dot2c_f32_bf16 v49, v108, v8
  v_dot2c_f32_bf16 v49, v109, v9
  v_dot2c_f32_bf16 v49, v110, v10
  v_dot2c_f32_bf16 v49, v111, v11
  v_dot2c_f32_bf16 v49, v112, v12
  v_dot2c_f32_bf16 v49, v113, v13
  v_dot2c_f32_bf16 v49, v114, v14
  v_dot2c_f32_bf16 v49, v115, v15
  v_dot2c_f32_bf16 v49, v116, v16
  v_dot2c_f32_bf16 v49, v117, v17
  v_dot2c_f32_bf16 v49, v118, v18
  v_dot2c_f32_bf16 v49, v119, v19
  v_add_f32_dpp v48, v48, v48 quad_perm:[1,0,3,2] row_mask:0xf bank_mask:0xf
  s_waitcnt vmcnt(4)
  buffer_load_dwordx4 v[96:99], v1, s[40:43], s59 offen offset:0 nt
  v_add_f32_dpp v49, v49, v49 quad_perm:[1,0,3,2] row_mask:0xf bank_mask:0xf
  v_add_f32_dpp v48, v48, v48 quad_perm:[2,3,0,1] row_mask:0xf bank_mask:0xf
  s_waitcnt vmcnt(4)
  v_add_f32_dpp v49, v49, v49 quad_perm:[2,3,0,1] row_mask:0xf bank_mask:0xf
  v_add_f32_dpp v48, v48, v48 row_half_mirror row_mask:0xf bank_mask:0xf
  buffer_load_dwordx4 v[100:103], v1, s[40:43], s59 offen offset:128 nt
  v_add_f32_dpp v49, v49, v49 row_half_mirror row_mask:0xf bank_mask:0xf
  s_waitcnt vmcnt(4)
  buffer_load_dwordx4 v[104:107], v1, s[40:43], s59 offen offset:256 nt
  s_waitcnt vmcnt(4)
  buffer_load_dwordx4 v[108:111], v1, s[40:43], s59 offen offset:3072 nt
  s_waitcnt vmcnt(4)
  buffer_load_dwordx4 v[112:115], v1, s[40:43], s59 offen offset:3200 nt
  s_waitcnt vmcnt(4)
  buffer_load_dwordx4 v[116:119], v1, s[40:43], s59 offen offset:3328 nt
  s_add_u32 s59, s59, 6144
  v_cvt_pk_bf16_f32 v50, v48, v49
  v_lshlrev_b32 v51, 16, v50
  v_and_b32 v52, s61, v50
  v_mul_f32 v51, s60, v51
  v_mul_f32 v52, s60, v52
  v_max3_f32 v56, v56, v51, v52
  v_cvt_pk_bf16_f32 v33, v51, v52
  s_waitcnt vmcnt(18)
  v_mov_b32 v48, 0
  v_mov_b32 v49, 0
  v_dot2c_f32_bf16 v48, v120, v8
  v_dot2c_f32_bf16 v48, v121, v9
  v_dot2c_f32_bf16 v48, v122, v10
  v_dot2c_f32_bf16 v48, v123, v11
  v_dot2c_f32_bf16 v48, v124, v12
  v_dot2c_f32_bf16 v48, v125, v13
  v_dot2c_f32_bf16 v48, v126, v14
  v_dot2c_f32_bf16 v48, v127, v15
  v_dot2c_f32_bf16 v48, v128, v16
  v_dot2c_f32_bf16 v48, v129, v17
  v_dot2c_f32_bf16 v48, v130, v18
  v_dot2c_f32_bf16 v48, v131, v19
  v_dot2c_f32_bf16 v49, v132, v8
  v_dot2c_f32_bf16 v49, v133, v9
  v_dot2c_f32_bf16 v49, v134, v10
  v_dot2c_f32_bf16 v49, v135, v11
  v_dot2c_f32_bf16 v49, v136, v12
  v_dot2c_f32_bf16 v49, v137, v13
  v_dot2c_f32_bf16 v49, v138, v14
  v_dot2c_f32_bf16 v49, v139, v15
  v_dot2c_f32_bf16 v49, v140, v16
  v_dot2c_f32_bf16 v49, v141, v17
  v_dot2c_f32_bf16 v49, v142, v18
  v_dot2c_f32_bf16 v49, v143, v19
  v_add_f32_dpp v48, v48, v48 quad_perm:[1,0,3,2] row_mask:0xf bank_mask:0xf
  s_waitcnt vmcnt(4)
  buffer_load_dwordx4 v[120:123], v1, s[40:43], s59 offen offset:0 nt
  v_add_f32_dpp v49, v49, v49 quad_perm:[1,0,3,2] row_mask:0xf bank_mask:0xf
  v_add_f32_dpp v48, v48, v48 quad_perm:[2,3,0,1] row_mask:0xf bank_mask:0xf
  s_waitcnt vmcnt(4)
  v_add_f32_dpp v49, v49, v49 quad_perm:[2,3,0,1] row_mask:0xf bank_mask:0xf
  v_add_f32_dpp v48, v48, v48 row_half_mirror row_mask:0xf bank_mask:0xf
  buffer_load_dwordx4 v[124:127], v1, s[40:43], s59 offen offset:128 nt
  v_add_f32_dpp v49, v49, v49 row_half_mirror row_mask:0xf bank_mask:0xf
  s_waitcnt vmcnt(4)
  buffer_load_dwordx4 v[128:131], v1, s[40:43], s59 offen offset:256 nt
  s_waitcnt vmcnt(4)
  buffer_load_dwordx4 v[132:135], v1, s[40:43], s59 offen offset:3072 nt
  s_waitcnt vmcnt(4)
  buffer_load_dwordx4 v[136:139], v1, s[40:43], s59 offen offset:3200 nt
  s_waitcnt vmcnt(4)
  buffer_load_dwordx4 v[140:143], v1, s[40:43], s59 offen offset:3328 nt
  s_add_u32 s59, s59, 6144
  v_cvt_pk_bf16_f32 v50, v48, v49
  v_lshlrev_b32 v51, 16, v50
  v_and_b32 v52, s61, v50
  v_mul_f32 v51, s60, v51
  v_mul_f32 v52, s60, v52
  v_max3_f32 v56, v56, v51, v52
  v_cvt_pk_bf16_f32 v34, v51, v52
  s_waitcnt vmcnt(18)
  v_mov_b32 v48, 0
  v_mov_b32 v49, 0
  v_dot2c_f32_bf16 v48, v144, v8
  v_dot2c_f32_bf16 v48, v145, v9
  v_dot2c_f32_bf16 v48, v146, v10
  v_dot2c_f32_bf16 v48, v147, v11
  v_dot2c_f32_bf16 v48, v148, v12
  v_dot2c_f32_bf16 v48, v149, v13
  v_dot2c_f32_bf16 v48, v150, v14
  v_dot2c_f32_bf16 v48, v151, v15
  v_dot2c_f32_bf16 v48, v152, v16
  v_dot2c_f32_bf16 v48, v153, v17
  v_dot2c_f32_bf16 v48, v154, v18
  v_dot2c_f32_bf16 v48, v155, v19
  v_dot2c_f32_bf16 v49, v156, v8
  v_dot2c_f32_bf16 v49, v157, v9
  v_dot2c_f32_bf16 v49, v158, v10
  v_dot2c_f32_bf16 v49, v159, v11
  v_dot2c_f32_bf16 v49, v160, v12
  v_dot2c_f32_bf16 v49, v161, v13
  v_dot2c_f32_bf16 v49, v162, v14
  v_dot2c_f32_bf16 v49, v163, v15
  v_dot2c_f32_bf16 v49, v164, v16
  v_dot2c_f32_bf16 v49, v165, v17
  v_dot2c_f32_bf16 v49, v166, v18
  v_dot2c_f32_bf16 v49, v167, v19
  v_add_f32_dpp v48, v48, v48 quad_perm:[1,0,3,2] row_mask:0xf bank_mask:0xf
  s_waitcnt vmcnt(4)
  buffer_load_dwordx4 v[144:147], v1, s[40:43], s59 offen offset:0 nt
  v_add_f32_dpp v49, v49, v49 quad_perm:[1,0,3,2] row_mask:0xf bank_mask:0xf
  v_add_f32_dpp v48, v48, v48 quad_perm:[2,3,0,1] row_mask:0xf bank_mask:0xf
  s_waitcnt vmcnt(4)
  v_add_f32_dpp v49, v49, v49 quad_perm:[2,3,0,1] row_mask:0xf bank_mask:0xf
  v_add_f32_dpp v48, v48, v48 row_half_mirror row_mask:0xf bank_mask:0xf
  buffer_load_dwordx4 v[148:151], v1, s[40:43], s59 offen offset:128 nt
  v_add_f32_dpp v49, v49, v49 row_half_mirror row_mask:0xf bank_mask:0xf
  s_waitcnt vmcnt(4)
  buffer_load_dwordx4 v[152:155], v1, s[40:43], s59 offen offset:256 nt
  s_waitcnt vmcnt(4)
  buffer_load_dwordx4 v[156:159], v1, s[40:43], s59 offen offset:3072 nt
  s_waitcnt vmcnt(4)
  buffer_load_dwordx4 v[160:163], v1, s[40:43], s59 offen offset:3200 nt
  s_waitcnt vmcnt(4)
  buffer_load_dwordx4 v[164:167], v1, s[40:43], s59 offen offset:3328 nt
  s_add_u32 s59, s59, 6144
  v_cvt_pk_bf16_f32 v50, v48, v49
  v_lshlrev_b32 v51, 16, v50
  v_and_b32 v52, s61, v50
  v_mul_f32 v51, s60, v51
  v_mul_f32 v52, s60, v52
  v_max3_f32 v56, v56, v51, v52
  v_cvt_pk_bf16_f32 v35, v51, v52
  s_waitcnt vmcnt(18)
  v_mov_b32 v48, 0
  v_mov_b32 v49, 0
  v_dot2c_f32_bf16 v48, v72, v8
  v_dot2c_f32_bf16 v48, v73, v9
  v_dot2c_f32_bf16 v48, v74, v10
  v_dot2c_f32_bf16 v48, v75, v11
  v_dot2c_f32_bf16 v48, v76, v12
  v_dot2c_f32_bf16 v48, v77, v13
  v_dot2c_f32_bf16 v48, v78, v14
  v_dot2c_f32_bf16 v48, v79, v15
  v_dot2c_f32_bf16 v48, v80, v16
  v_dot2c_f32_bf16 v48, v81, v17
  v_dot2c_f32_bf16 v48, v82, v18
  v_dot2c_f32_bf16 v48, v83, v19
  v_dot2c_f32_bf16 v49, v84, v8
  v_dot2c_f32_bf16 v49, v85, v9
  v_dot2c_f32_bf16 v49, v86, v10
  v_dot2c_f32_bf16 v49, v87, v11
  v_dot2c_f32_bf16 v49, v88, v12
  v_dot2c_f32_bf16 v49, v89, v13
  v_dot2c_f32_bf16 v49, v90, v14
  v_dot2c_f32_bf16 v49, v91, v15
  v_dot2c_f32_bf16 v49, v92, v16
  v_dot2c_f32_bf16 v49, v93, v17
  v_dot2c_f32_bf16 v49, v94, v18
  v_dot2c_f32_bf16 v49, v95, v19
  v_add_f32_dpp v48, v48, v48 quad_perm:[1,0,3,2] row_mask:0xf bank_mask:0xf
  s_waitcnt vmcnt(4)
  buffer_load_dwordx4 v[72:75], v1, s[40:43], s59 offen offset:0 nt
  v_add_f32_dpp v49, v49, v49 quad_perm:[1,0,3,2] row_mask:0xf bank_mask:0xf
  v_add_f32_dpp v48, v48, v48 quad_perm:[2,3,0,1] row_mask:0xf bank_mask:0xf
  s_waitcnt vmcnt(4)
  v_add_f32_dpp v49, v49, v49 quad_perm:[2,3,0,1] row_mask:0xf bank_mask:0xf
  v_add_f32_dpp v48, v48, v48 row_half_mirror row_mask:0xf bank_mask:0xf
  buffer_load_dwordx4 v[76:79], v1, s[40:43], s59 offen offset:128 nt
  v_add_f32_dpp v49, v49, v49 row_half_mirror row_mask:0xf bank_mask:0xf
  s_waitcnt vmcnt(4)
  buffer_load_dwordx4 v[80:83], v1, s[40:43], s59 offen offset:256 nt
  s_waitcnt vmcnt(4)
  buffer_load_dwordx4 v[84:87], v1, s[40:43], s59 offen offset:3072 nt
  s_waitcnt vmcnt(4)
  buffer_load_dwordx4 v[88:91], v1, s[40:43], s59 offen offset:3200 nt
  s_waitcnt vmcnt(4)
  buffer_load_dwordx4 v[92:95], v1, s[40:43], s59 offen offset:3328 nt
  s_add_u32 s59, s59, 6144
  v_cvt_pk_bf16_f32 v50, v48, v49
  v_lshlrev_b32 v51, 16, v50
  v_and_b32 v52, s61, v50
  v_mul_f32 v51, s60, v51
  v_mul_f32 v52, s60, v52
  v_max3_f32 v56, v56, v51, v52
  v_cvt_pk_bf16_f32 v36, v51, v52
  s_waitcnt vmcnt(18)
  v_mov_b32 v48, 0
  v_mov_b32 v49, 0
  v_dot2c_f32_bf16 v48, v96, v8
  v_dot2c_f32_bf16 v48, v97, v9
  v_dot2c_f32_bf16 v48, v98, v10
  v_dot2c_f32_bf16 v48, v99, v11
  v_dot2c_f32_bf16 v48, v100, v12
  v_dot2c_f32_bf16 v48, v101, v13
  v_dot2c_f32_bf16 v48, v102, v14
  v_dot2c_f32_bf16 v48, v103, v15
  v_dot2c_f32_bf16 v48, v104, v16
  v_dot2c_f32_bf16 v48, v105, v17
  v_dot2c_f32_bf16 v48, v106, v18
  v_dot2c_f32_bf16 v48, v107, v19
  v_dot2c_f32_bf16 v49, v108, v8
  v_dot2c_f32_bf16 v49, v109, v9
  v_dot2c_f32_bf16 v49, v110, v10
  v_dot2c_f32_bf16 v49, v111, v11
  v_dot2c_f32_bf16 v49, v112, v12
  v_dot2c_f32_bf16 v49, v113, v13
  v_dot2c_f32_bf16 v49, v114, v14
  v_dot2c_f32_bf16 v49, v115, v15
  v_dot2c_f32_bf16 v49, v116, v16
  v_dot2c_f32_bf16 v49, v117, v17
  v_dot2c_f32_bf16 v49, v118, v18
  v_dot2c_f32_bf16 v49, v119, v19
  v_add_f32_dpp v48, v48, v48 quad_perm:[1,0,3,2] row_mask:0xf bank_mask:0xf
  s_waitcnt vmcnt(4)
  buffer_load_dwordx4 v[96:99], v1, s[40:43], s59 offen offset:0 nt
  v_add_f32_dpp v49, v49, v49 quad_perm:[1,0,3,2] row_mask:0xf bank_mask:0xf
  v_add_f32_dpp v48, v48, v48 quad_perm:[2,3,0,1] row_mask:0xf bank_mask:0xf
  s_waitcnt vmcnt(4)
  v_add_f32_dpp v49, v49, v49 quad_perm:[2,3,0,1] row_mask:0xf bank_mask:0xf
  v_add_f32_dpp v48, v48, v48 row_half_mirror row_mask:0xf bank_mask:0xf
  buffer_load_dwordx4 v[100:103], v1, s[40:43], s59 offen offset:128 nt
  v_add_f32_dpp v49, v49, v49 row_half_mirror row_mask:0xf bank_mask:0xf
  s_waitcnt vmcnt(4)
  buffer_load_dwordx4 v[104:107], v1, s[40:43], s59 offen offset:256 nt
  s_waitcnt vmcnt(4)
  buffer_load_dwordx4 v[108:111], v1, s[40:43], s59 offen offset:3072 nt
  s_waitcnt vmcnt(4)
  buffer_load_dwordx4 v[112:115], v1, s[40:43], s59 offen offset:3200 nt
  s_waitcnt vmcnt(4)
  buffer_load_dwordx4 v[116:119], v1, s[40:43], s59 offen offset:3328 nt
  s_add_u32 s59, s59, 6144
  v_cvt_pk_bf16_f32 v50, v48, v49
  v_lshlrev_b32 v51, 16, v50
  v_and_b32 v52, s61, v50
  v_mul_f32 v51, s60, v51
  v_mul_f32 v52, s60, v52
  v_max3_f32 v56, v56, v51, v52
  v_cvt_pk_bf16_f32 v37, v51, v52
  s_waitcnt vmcnt(18)
  v_mov_b32 v48, 0
  v_mov_b32 v49, 0
  v_dot2c_f32_bf16 v48, v120, v8
  v_dot2c_f32_bf16 v48, v121, v9
  v_dot2c_f32_bf16 v48, v122, v10
  v_dot2c_f32_bf16 v48, v123, v11
  v_dot2c_f32_bf16 v48, v124, v12
  v_dot2c_f32_bf16 v48, v125, v13
  v_dot2c_f32_bf16 v48, v126, v14
  v_dot2c_f32_bf16 v48, v127, v15
  v_dot2c_f32_bf16 v48, v128, v16
  v_dot2c_f32_bf16 v48, v129, v17
  v_dot2c_f32_bf16 v48, v130, v18
  v_dot2c_f32_bf16 v48, v131, v19
  v_dot2c_f32_bf16 v49, v132, v8
  v_dot2c_f32_bf16 v49, v133, v9
  v_dot2c_f32_bf16 v49, v134, v10
  v_dot2c_f32_bf16 v49, v135, v11
  v_dot2c_f32_bf16 v49, v136, v12
  v_dot2c_f32_bf16 v49, v137, v13
  v_dot2c_f32_bf16 v49, v138, v14
  v_dot2c_f32_bf16 v49, v139, v15
  v_dot2c_f32_bf16 v49, v140, v16
  v_dot2c_f32_bf16 v49, v141, v17
  v_dot2c_f32_bf16 v49, v142, v18
  v_dot2c_f32_bf16 v49, v143, v19
  v_add_f32_dpp v48, v48, v48 quad_perm:[1,0,3,2] row_mask:0xf bank_mask:0xf
  s_waitcnt vmcnt(4)
  buffer_load_dwordx4 v[120:123], v1, s[40:43], s59 offen offset:0 nt
  v_add_f32_dpp v49, v49, v49 quad_perm:[1,0,3,2] row_mask:0xf bank_mask:0xf
  v_add_f32_dpp v48, v48, v48 quad_perm:[2,3,0,1] row_mask:0xf bank_mask:0xf
  s_waitcnt vmcnt(4)
  v_add_f32_dpp v49, v49, v49 quad_perm:[2,3,0,1] row_mask:0xf bank_mask:0xf
  v_add_f32_dpp v48, v48, v48 row_half_mirror row_mask:0xf bank_mask:0xf
  buffer_load_dwordx4 v[124:127], v1, s[40:43], s59 offen offset:128 nt
  v_add_f32_dpp v49, v49, v49 row_half_mirror row_mask:0xf bank_mask:0xf
  s_waitcnt vmcnt(4)
  buffer_load_dwordx4 v[128:131], v1, s[40:43], s59 offen offset:256 nt
  s_waitcnt vmcnt(4)
  buffer_load_dwordx4 v[132:135], v1, s[40:43], s59 offen offset:3072 nt
  s_waitcnt vmcnt(4)
  buffer_load_dwordx4 v[136:139], v1, s[40:43], s59 offen offset:3200 nt
  s_waitcnt vmcnt(4)
  buffer_load_dwordx4 v[140:143], v1, s[40:43], s59 offen offset:3328 nt
  s_add_u32 s59, s59, 6144
  v_cvt_pk_bf16_f32 v50, v48, v49
  v_lshlrev_b32 v51, 16, v50
  v_and_b32 v52, s61, v50
  v_mul_f32 v51, s60, v51
  v_mul_f32 v52, s60, v52
  v_max3_f32 v56, v56, v51, v52
  v_cvt_pk_bf16_f32 v38, v51, v52
  s_waitcnt vmcnt(18)
  v_mov_b32 v48, 0
  v_mov_b32 v49, 0
  v_dot2c_f32_bf16 v48, v144, v8
  v_dot2c_f32_bf16 v48, v145, v9
  v_dot2c_f32_bf16 v48, v146, v10
  v_dot2c_f32_bf16 v48, v147, v11
  v_dot2c_f32_bf16 v48, v148, v12
  v_dot2c_f32_bf16 v48, v149, v13
  v_dot2c_f32_bf16 v48, v150, v14
  v_dot2c_f32_bf16 v48, v151, v15
  v_dot2c_f32_bf16 v48, v152, v16
  v_dot2c_f32_bf16 v48, v153, v17
  v_dot2c_f32_bf16 v48, v154, v18
  v_dot2c_f32_bf16 v48, v155, v19
  v_dot2c_f32_bf16 v49, v156, v8
  v_dot2c_f32_bf16 v49, v157, v9
  v_dot2c_f32_bf16 v49, v158, v10
  v_dot2c_f32_bf16 v49, v159, v11
  v_dot2c_f32_bf16 v49, v160, v12
  v_dot2c_f32_bf16 v49, v161, v13
  v_dot2c_f32_bf16 v49, v162, v14
  v_dot2c_f32_bf16 v49, v163, v15
  v_dot2c_f32_bf16 v49, v164, v16
  v_dot2c_f32_bf16 v49, v165, v17
  v_dot2c_f32_bf16 v49, v166, v18
  v_dot2c_f32_bf16 v49, v167, v19
  v_add_f32_dpp v48, v48, v48 quad_perm:[1,0,3,2] row_mask:0xf bank_mask:0xf
  s_waitcnt vmcnt(4)
  buffer_load_dwordx4 v[144:147], v1, s[40:43], s59 offen offset:0 nt
  v_add_f32_dpp v49, v49, v49 quad_perm:[1,0,3,2] row_mask:0xf bank_mask:0xf
  v_add_f32_dpp v48, v48, v48 quad_perm:[2,3,0,1] row_mask:0xf bank_mask:0xf
  s_waitcnt vmcnt(4)
  v_add_f32_dpp v49, v49, v49 quad_perm:[2,3,0,1] row_mask:0xf bank_mask:0xf
  v_add_f32_dpp v48, v48, v48 row_half_mirror row_mask:0xf bank_mask:0xf
  buffer_load_dwordx4 v[148:151], v1, s[40:43], s59 offen offset:128 nt
  v_add_f32_dpp v49, v49, v49 row_half_mirror row_mask:0xf bank_mask:0xf
  s_waitcnt vmcnt(4)
  buffer_load_dwordx4 v[152:155], v1, s[40:43], s59 offen offset:256 nt
  s_waitcnt vmcnt(4)
  buffer_load_dwordx4 v[156:159], v1, s[40:43], s59 offen offset:3072 nt
  s_waitcnt vmcnt(4)
  buffer_load_dwordx4 v[160:163], v1, s[40:43], s59 offen offset:3200 nt
  s_waitcnt vmcnt(4)
  buffer_load_dwordx4 v[164:167], v1, s[40:43], s59 offen offset:3328 nt
  s_add_u32 s59, s59, 6144
  v_cvt_pk_bf16_f32 v50, v48, v49
  v_lshlrev_b32 v51, 16, v50
  v_and_b32 v52, s61, v50
  v_mul_f32 v51, s60, v51
  v_mul_f32 v52, s60, v52
  v_max3_f32 v56, v56, v51, v52
  v_cvt_pk_bf16_f32 v39, v51, v52
  s_waitcnt vmcnt(18)
  v_mov_b32 v48, 0
  v_mov_b32 v49, 0
  v_dot2c_f32_bf16 v48, v72, v8
  v_dot2c_f32_bf16 v48, v73, v9
  v_dot2c_f32_bf16 v48, v74, v10
  v_dot2c_f32_bf16 v48, v75, v11
  v_dot2c_f32_bf16 v48, v76, v12
  v_dot2c_f32_bf16 v48, v77, v13
  v_dot2c_f32_bf16 v48, v78, v14
  v_dot2c_f32_bf16 v48, v79, v15
  v_dot2c_f32_bf16 v48, v80, v16
  v_dot2c_f32_bf16 v48, v81, v17
  v_dot2c_f32_bf16 v48, v82, v18
  v_dot2c_f32_bf16 v48, v83, v19
  v_dot2c_f32_bf16 v49, v84, v8
  v_dot2c_f32_bf16 v49, v85, v9
  v_dot2c_f32_bf16 v49, v86, v10
  v_dot2c_f32_bf16 v49, v87, v11
  v_dot2c_f32_bf16 v49, v88, v12
  v_dot2c_f32_bf16 v49, v89, v13
  v_dot2c_f32_bf16 v49, v90, v14
  v_dot2c_f32_bf16 v49, v91, v15
  v_dot2c_f32_bf16 v49, v92, v16
  v_dot2c_f32_bf16 v49, v93, v17
  v_dot2c_f32_bf16 v49, v94, v18
  v_dot2c_f32_bf16 v49, v95, v19
  v_add_f32_dpp v48, v48, v48 quad_perm:[1,0,3,2] row_mask:0xf bank_mask:0xf
  s_waitcnt vmcnt(4)
  buffer_load_dwordx4 v[72:75], v1, s[40:43], s59 offen offset:0 nt
  v_add_f32_dpp v49, v49, v49 quad_perm:[1,0,3,2] row_mask:0xf bank_mask:0xf
  v_add_f32_dpp v48, v48, v48 quad_perm:[2,3,0,1] row_mask:0xf bank_mask:0xf
  s_waitcnt vmcnt(4)
  v_add_f32_dpp v49, v49, v49 quad_perm:[2,3,0,1] row_mask:0xf bank_mask:0xf
  v_add_f32_dpp v48, v48, v48 row_half_mirror row_mask:0xf bank_mask:0xf
  buffer_load_dwordx4 v[76:79], v1, s[40:43], s59 offen offset:128 nt
  v_add_f32_dpp v49, v49, v49 row_half_mirror row_mask:0xf bank_mask:0xf
  s_waitcnt vmcnt(4)
  buffer_load_dwordx4 v[80:83], v1, s[40:43], s59 offen offset:256 nt
  s_waitcnt vmcnt(4)
  buffer_load_dwordx4 v[84:87], v1, s[40:43], s59 offen offset:3072 nt
  s_waitcnt vmcnt(4)
  buffer_load_dwordx4 v[88:91], v1, s[40:43], s59 offen offset:3200 nt
  s_waitcnt vmcnt(4)
  buffer_load_dwordx4 v[92:95], v1, s[40:43], s59 offen offset:3328 nt
  s_add_u32 s59, s59, 6144
  v_cvt_pk_bf16_f32 v50, v48, v49
  v_lshlrev_b32 v51, 16, v50
  v_and_b32 v52, s61, v50
  v_mul_f32 v51, s60, v51
  v_mul_f32 v52, s60, v52
  v_max3_f32 v56, v56, v51, v52
  v_cvt_pk_bf16_f32 v40, v51, v52
  s_waitcnt vmcnt(18)
  v_mov_b32 v48, 0
  v_mov_b32 v49, 0
  v_dot2c_f32_bf16 v48, v96, v8
  v_dot2c_f32_bf16 v48, v97, v9
  v_dot2c_f32_bf16 v48, v98, v10
  v_dot2c_f32_bf16 v48, v99, v11
  v_dot2c_f32_bf16 v48, v100, v12
  v_dot2c_f32_bf16 v48, v101, v13
  v_dot2c_f32_bf16 v48, v102, v14
  v_dot2c_f32_bf16 v48, v103, v15
  v_dot2c_f32_bf16 v48, v104, v16
  v_dot2c_f32_bf16 v48, v105, v17
  v_dot2c_f32_bf16 v48, v106, v18
  v_dot2c_f32_bf16 v48, v107, v19
  v_dot2c_f32_bf16 v49, v108, v8
  v_dot2c_f32_bf16 v49, v109, v9
  v_dot2c_f32_bf16 v49, v110, v10
  v_dot2c_f32_bf16 v49, v111, v11
  v_dot2c_f32_bf16 v49, v112, v12
  v_dot2c_f32_bf16 v49, v113, v13
  v_dot2c_f32_bf16 v49, v114, v14
  v_dot2c_f32_bf16 v49, v115, v15
  v_dot2c_f32_bf16 v49, v116, v16
  v_dot2c_f32_bf16 v49, v117, v17
  v_dot2c_f32_bf16 v49, v118, v18
  v_dot2c_f32_bf16 v49, v119, v19
  v_add_f32_dpp v48, v48, v48 quad_perm:[1,0,3,2] row_mask:0xf bank_mask:0xf
  s_waitcnt vmcnt(4)
  buffer_load_dwordx4 v[96:99], v1, s[40:43], s59 offen offset:0 nt
  v_add_f32_dpp v49, v49, v49 quad_perm:[1,0,3,2] row_mask:0xf bank_mask:0xf
  v_add_f32_dpp v48, v48, v48 quad_perm:[2,3,0,1] row_mask:0xf bank_mask:0xf
  s_waitcnt vmcnt(4)
  v_add_f32_dpp v49, v49, v49 quad_perm:[2,3,0,1] row_mask:0xf bank_mask:0xf
  v_add_f32_dpp v48, v48, v48 row_half_mirror row_mask:0xf bank_mask:0xf
  buffer_load_dwordx4 v[100:103], v1, s[40:43], s59 offen offset:128 nt
  v_add_f32_dpp v49, v49, v49 row_half_mirror row_mask:0xf bank_mask:0xf
  s_waitcnt vmcnt(4)
  buffer_load_dwordx4 v[104:107], v1, s[40:43], s59 offen offset:256 nt
  s_waitcnt vmcnt(4)
  buffer_load_dwordx4 v[108:111], v1, s[40:43], s59 offen offset:3072 nt
  s_waitcnt vmcnt(4)
  buffer_load_dwordx4 v[112:115], v1, s[40:43], s59 offen offset:3200 nt
  s_waitcnt vmcnt(4)
  buffer_load_dwordx4 v[116:119], v1, s[40:43], s59 offen offset:3328 nt
  s_add_u32 s59, s59, 6144
  v_cvt_pk_bf16_f32 v50, v48, v49
  v_lshlrev_b32 v51, 16, v50
  v_and_b32 v52, s61, v50
  v_mul_f32 v51, s60, v51
  v_mul_f32 v52, s60, v52
  v_max3_f32 v56, v56, v51, v52
  v_cvt_pk_bf16_f32 v41, v51, v52
  s_waitcnt vmcnt(18)
  v_mov_b32 v48, 0
  v_mov_b32 v49, 0
  v_dot2c_f32_bf16 v48, v120, v8
  v_dot2c_f32_bf16 v48, v121, v9
  v_dot2c_f32_bf16 v48, v122, v10
  v_dot2c_f32_bf16 v48, v123, v11
  v_dot2c_f32_bf16 v48, v124, v12
  v_dot2c_f32_bf16 v48, v125, v13
  v_dot2c_f32_bf16 v48, v126, v14
  v_dot2c_f32_bf16 v48, v127, v15
  v_dot2c_f32_bf16 v48, v128, v16
  v_dot2c_f32_bf16 v48, v129, v17
  v_dot2c_f32_bf16 v48, v130, v18
  v_dot2c_f32_bf16 v48, v131, v19
  v_dot2c_f32_bf16 v49, v132, v8
  v_dot2c_f32_bf16 v49, v133, v9
  v_dot2c_f32_bf16 v49, v134, v10
  v_dot2c_f32_bf16 v49, v135, v11
  v_dot2c_f32_bf16 v49, v136, v12
  v_dot2c_f32_bf16 v49, v137, v13
  v_dot2c_f32_bf16 v49, v138, v14
  v_dot2c_f32_bf16 v49, v139, v15
  v_dot2c_f32_bf16 v49, v140, v16
  v_dot2c_f32_bf16 v49, v141, v17
  v_dot2c_f32_bf16 v49, v142, v18
  v_dot2c_f32_bf16 v49, v143, v19
  v_add_f32_dpp v48, v48, v48 quad_perm:[1,0,3,2] row_mask:0xf bank_mask:0xf
  s_waitcnt vmcnt(4)
  buffer_load_dwordx4 v[120:123], v1, s[40:43], s59 offen offset:0 nt
  v_add_f32_dpp v49, v49, v49 quad_perm:[1,0,3,2] row_mask:0xf bank_mask:0xf
  v_add_f32_dpp v48, v48, v48 quad_perm:[2,3,0,1] row_mask:0xf bank_mask:0xf
  s_waitcnt vmcnt(4)
  v_add_f32_dpp v49, v49, v49 quad_perm:[2,3,0,1] row_mask:0xf bank_mask:0xf
  v_add_f32_dpp v48, v48, v48 row_half_mirror row_mask:0xf bank_mask:0xf
  buffer_load_dwordx4 v[124:127], v1, s[40:43], s59 offen offset:128 nt
  v_add_f32_dpp v49, v49, v49 row_half_mirror row_mask:0xf bank_mask:0xf
  s_waitcnt vmcnt(4)
  buffer_load_dwordx4 v[128:131], v1, s[40:43], s59 offen offset:256 nt
  s_waitcnt vmcnt(4)
  buffer_load_dwordx4 v[132:135], v1, s[40:43], s59 offen offset:3072 nt
  s_waitcnt vmcnt(4)
  buffer_load_dwordx4 v[136:139], v1, s[40:43], s59 offen offset:3200 nt
  s_waitcnt vmcnt(4)
  buffer_load_dwordx4 v[140:143], v1, s[40:43], s59 offen offset:3328 nt
  s_add_u32 s59, s59, 6144
  s_mov_b64 exec, 1
  ds_add_u32 v240, v241 offset:4048
  s_mov_b64 exec, -1
  v_cvt_pk_bf16_f32 v50, v48, v49
  v_lshlrev_b32 v51, 16, v50
  v_and_b32 v52, s61, v50
  v_mul_f32 v51, s60, v51
  v_mul_f32 v52, s60, v52
  v_max3_f32 v56, v56, v51, v52
  v_cvt_pk_bf16_f32 v42, v51, v52
  s_waitcnt vmcnt(18)
  v_mov_b32 v48, 0
  v_mov_b32 v49, 0
  v_dot2c_f32_bf16 v48, v144, v8
  v_dot2c_f32_bf16 v48, v145, v9
  v_dot2c_f32_bf16 v48, v146, v10
  v_dot2c_f32_bf16 v48, v147, v11
  v_dot2c_f32_bf16 v48, v148, v12
  v_dot2c_f32_bf16 v48, v149, v13
  v_dot2c_f32_bf16 v48, v150, v14
  v_dot2c_f32_bf16 v48, v151, v15
  v_dot2c_f32_bf16 v48, v152, v16
  v_dot2c_f32_bf16 v48, v153, v17
  v_dot2c_f32_bf16 v48, v154, v18
  v_dot2c_f32_bf16 v48, v155, v19
  v_dot2c_f32_bf16 v49, v156, v8
  v_dot2c_f32_bf16 v49, v157, v9
  v_dot2c_f32_bf16 v49, v158, v10
  v_dot2c_f32_bf16 v49, v159, v11
  v_dot2c_f32_bf16 v49, v160, v12
  v_dot2c_f32_bf16 v49, v161, v13
  v_dot2c_f32_bf16 v49, v162, v14
  v_dot2c_f32_bf16 v49, v163, v15
  v_dot2c_f32_bf16 v49, v164, v16
  v_dot2c_f32_bf16 v49, v165, v17
  v_dot2c_f32_bf16 v49, v166, v18
  v_dot2c_f32_bf16 v49, v167, v19
  v_add_f32_dpp v48, v48, v48 quad_perm:[1,0,3,2] row_mask:0xf bank_mask:0xf
  s_waitcnt vmcnt(4)
  buffer_load_dwordx4 v[144:147], v1, s[40:43], s59 offen offset:0 nt
  v_add_f32_dpp v49, v49, v49 quad_perm:[1,0,3,2] row_mask:0xf bank_mask:0xf
  v_add_f32_dpp v48, v48, v48 quad_perm:[2,3,0,1] row_mask:0xf bank_mask:0xf
  s_waitcnt vmcnt(4)
  v_add_f32_dpp v49, v49, v49 quad_perm:[2,3,0,1] row_mask:0xf bank_mask:0xf
  v_add_f32_dpp v48, v48, v48 row_half_mirror row_mask:0xf bank_mask:0xf
  buffer_load_dwordx4 v[148:151], v1, s[40:43], s59 offen offset:128 nt
  v_add_f32_dpp v49, v49, v49 row_half_mirror row_mask:0xf bank_mask:0xf
  s_waitcnt vmcnt(4)
  buffer_load_dwordx4 v[152:155], v1, s[40:43], s59 offen offset:256 nt
  s_waitcnt vmcnt(4)
  buffer_load_dwordx4 v[156:159], v1, s[40:43], s59 offen offset:3072 nt
  s_waitcnt vmcnt(4)
  buffer_load_dwordx4 v[160:163], v1, s[40:43], s59 offen offset:3200 nt
  s_waitcnt vmcnt(4)
  buffer_load_dwordx4 v[164:167], v1, s[40:43], s59 offen offset:3328 nt
  s_add_u32 s59, s59, 6144
  v_cvt_pk_bf16_f32 v50, v48, v49
  v_lshlrev_b32 v51, 16, v50
  v_and_b32 v52, s61, v50
  v_mul_f32 v51, s60, v51
  v_mul_f32 v52, s60, v52
  v_max3_f32 v56, v56, v51, v52
  v_cvt_pk_bf16_f32 v43, v51, v52
  s_waitcnt vmcnt(18)
  v_mov_b32 v48, 0
  v_mov_b32 v49, 0
  v_dot2c_f32_bf16 v48, v72, v8
  v_dot2c_f32_bf16 v48, v73, v9
  v_dot2c_f32_bf16 v48, v74, v10
  v_dot2c_f32_bf16 v48, v75, v11
  v_dot2c_f32_bf16 v48, v76, v12
  v_dot2c_f32_bf16 v48, v77, v13
  v_dot2c_f32_bf16 v48, v78, v14
  v_dot2c_f32_bf16 v48, v79, v15
  v_dot2c_f32_bf16 v48, v80, v16
  v_dot2c_f32_bf16 v48, v81, v17
  v_dot2c_f32_bf16 v48, v82, v18
  v_dot2c_f32_bf16 v48, v83, v19
  v_dot2c_f32_bf16 v49, v84, v8
  v_dot2c_f32_bf16 v49, v85, v9
  v_dot2c_f32_bf16 v49, v86, v10
  v_dot2c_f32_bf16 v49, v87, v11
  v_dot2c_f32_bf16 v49, v88, v12
  v_dot2c_f32_bf16 v49, v89, v13
  v_dot2c_f32_bf16 v49, v90, v14
  v_dot2c_f32_bf16 v49, v91, v15
  v_dot2c_f32_bf16 v49, v92, v16
  v_dot2c_f32_bf16 v49, v93, v17
  v_dot2c_f32_bf16 v49, v94, v18
  v_dot2c_f32_bf16 v49, v95, v19
  v_add_f32_dpp v48, v48, v48 quad_perm:[1,0,3,2] row_mask:0xf bank_mask:0xf
  s_mov_b32 s59, s58
  s_waitcnt vmcnt(4)
  v_add_f32_dpp v49, v49, v49 quad_perm:[1,0,3,2] row_mask:0xf bank_mask:0xf
  v_add_f32_dpp v48, v48, v48 quad_perm:[2,3,0,1] row_mask:0xf bank_mask:0xf
  buffer_load_dwordx4 v[72:75], v1, s[44:47], s59 offen offset:0 nt
  v_add_f32_dpp v49, v49, v49 quad_perm:[2,3,0,1] row_mask:0xf bank_mask:0xf
  v_add_f32_dpp v48, v48, v48 row_half_mirror row_mask:0xf bank_mask:0xf
  s_waitcnt vmcnt(4)
  v_add_f32_dpp v49, v49, v49 row_half_mirror row_mask:0xf bank_mask:0xf
  buffer_load_dwordx4 v[76:79], v1, s[44:47], s59 offen offset:128 nt
  s_waitcnt vmcnt(4)
  buffer_load_dwordx4 v[80:83], v1, s[44:47], s59 offen offset:256 nt
  s_waitcnt vmcnt(4)
  buffer_load_dwordx4 v[84:87], v1, s[44:47], s59 offen offset:3072 nt
  s_waitcnt vmcnt(4)
  buffer_load_dwordx4 v[88:91], v1, s[44:47], s59 offen offset:3200 nt
  s_waitcnt vmcnt(4)
  buffer_load_dwordx4 v[92:95], v1, s[44:47], s59 offen offset:3328 nt
  s_add_u32 s59, s59, 6144
  v_cvt_pk_bf16_f32 v50, v48, v49
  v_lshlrev_b32 v51, 16, v50
  v_and_b32 v52, s61, v50
  v_mul_f32 v51, s60, v51
  v_mul_f32 v52, s60, v52
  v_max3_f32 v56, v56, v51, v52
  v_cvt_pk_bf16_f32 v44, v51, v52
  s_waitcnt vmcnt(18)
  v_mov_b32 v48, 0
  v_mov_b32 v49, 0
  v_dot2c_f32_bf16 v48, v96, v8
  v_dot2c_f32_bf16 v48, v97, v9
  v_dot2c_f32_bf16 v48, v98, v10
  v_dot2c_f32_bf16 v48, v99, v11
  v_dot2c_f32_bf16 v48, v100, v12
  v_dot2c_f32_bf16 v48, v101, v13
  v_dot2c_f32_bf16 v48, v102, v14
  v_dot2c_f32_bf16 v48, v103, v15
  v_dot2c_f32_bf16 v48, v104, v16
  v_dot2c_f32_bf16 v48, v105, v17
  v_dot2c_f32_bf16 v48, v106, v18
  v_dot2c_f32_bf16 v48, v107, v19
  v_dot2c_f32_bf16 v49, v108, v8
  v_dot2c_f32_bf16 v49, v109, v9
  v_dot2c_f32_bf16 v49, v110, v10
  v_dot2c_f32_bf16 v49, v111, v11
  v_dot2c_f32_bf16 v49, v112, v12
  v_dot2c_f32_bf16 v49, v113, v13
  v_dot2c_f32_bf16 v49, v114, v14
  v_dot2c_f32_bf16 v49, v115, v15
  v_dot2c_f32_bf16 v49, v116, v16
  v_dot2c_f32_bf16 v49, v117, v17
  v_dot2c_f32_bf16 v49, v118, v18
  v_dot2c_f32_bf16 v49, v119, v19
  v_add_f32_dpp v48, v48, v48 quad_perm:[1,0,3,2] row_mask:0xf bank_mask:0xf
  s_waitcnt vmcnt(4)
  buffer_load_dwordx4 v[96:99], v1, s[44:47], s59 offen offset:0 nt
  v_add_f32_dpp v49, v49, v49 quad_perm:[1,0,3,2] row_mask:0xf bank_mask:0xf
  v_add_f32_dpp v48, v48, v48 quad_perm:[2,3,0,1] row_mask:0xf bank_mask:0xf
  s_waitcnt vmcnt(4)
  v_add_f32_dpp v49, v49, v49 quad_perm:[2,3,0,1] row_mask:0xf bank_mask:0xf
  v_add_f32_dpp v48, v48, v48 row_half_mirror row_mask:0xf bank_mask:0xf
  buffer_load_dwordx4 v[100:103], v1, s[44:47], s59 offen offset:128 nt
  v_add_f32_dpp v49, v49, v49 row_half_mirror row_mask:0xf bank_mask:0xf
  s_waitcnt vmcnt(4)
  buffer_load_dwordx4 v[104:107], v1, s[44:47], s59 offen offset:256 nt
  s_waitcnt vmcnt(4)
  buffer_load_dwordx4 v[108:111], v1, s[44:47], s59 offen offset:3072 nt
  s_waitcnt vmcnt(4)
  buffer_load_dwordx4 v[112:115], v1, s[44:47], s59 offen offset:3200 nt
  s_waitcnt vmcnt(4)
  buffer_load_dwordx4 v[116:119], v1, s[44:47], s59 offen offset:3328 nt
  s_add_u32 s59, s59, 6144
  v_cvt_pk_bf16_f32 v50, v48, v49
  v_lshlrev_b32 v51, 16, v50
  v_and_b32 v52, s61, v50
  v_mul_f32 v51, s60, v51
  v_mul_f32 v52, s60, v52
  v_max3_f32 v56, v56, v51, v52
  v_cvt_pk_bf16_f32 v45, v51, v52
  s_waitcnt vmcnt(18)
  v_mov_b32 v48, 0
  v_mov_b32 v49, 0
  v_dot2c_f32_bf16 v48, v120, v8
  v_dot2c_f32_bf16 v48, v121, v9
  v_dot2c_f32_bf16 v48, v122, v10
  v_dot2c_f32_bf16 v48, v123, v11
  v_dot2c_f32_bf16 v48, v124, v12
  v_dot2c_f32_bf16 v48, v125, v13
  v_dot2c_f32_bf16 v48, v126, v14
  v_dot2c_f32_bf16 v48, v127, v15
  v_dot2c_f32_bf16 v48, v128, v16
  v_dot2c_f32_bf16 v48, v129, v17
  v_dot2c_f32_bf16 v48, v130, v18
  v_dot2c_f32_bf16 v48, v131, v19
  v_dot2c_f32_bf16 v49, v132, v8
  v_dot2c_f32_bf16 v49, v133, v9
  v_dot2c_f32_bf16 v49, v134, v10
  v_dot2c_f32_bf16 v49, v135, v11
  v_dot2c_f32_bf16 v49, v136, v12
  v_dot2c_f32_bf16 v49, v137, v13
  v_dot2c_f32_bf16 v49, v138, v14
  v_dot2c_f32_bf16 v49, v139, v15
  v_dot2c_f32_bf16 v49, v140, v16
  v_dot2c_f32_bf16 v49, v141, v17
  v_dot2c_f32_bf16 v49, v142, v18
  v_dot2c_f32_bf16 v49, v143, v19
  v_add_f32_dpp v48, v48, v48 quad_perm:[1,0,3,2] row_mask:0xf bank_mask:0xf
  s_waitcnt vmcnt(4)
  buffer_load_dwordx4 v[120:123], v1, s[44:47], s59 offen offset:0 nt
  v_add_f32_dpp v49, v49, v49 quad_perm:[1,0,3,2] row_mask:0xf bank_mask:0xf
  v_add_f32_dpp v48, v48, v48 quad_perm:[2,3,0,1] row_mask:0xf bank_mask:0xf
  s_waitcnt vmcnt(4)
  v_add_f32_dpp v49, v49, v49 quad_perm:[2,3,0,1] row_mask:0xf bank_mask:0xf
  v_add_f32_dpp v48, v48, v48 row_half_mirror row_mask:0xf bank_mask:0xf
  buffer_load_dwordx4 v[124:127], v1, s[44:47], s59 offen offset:128 nt
  v_add_f32_dpp v49, v49, v49 row_half_mirror row_mask:0xf bank_mask:0xf
  s_waitcnt vmcnt(4)
  buffer_load_dwordx4 v[128:131], v1, s[44:47], s59 offen offset:256 nt
  s_waitcnt vmcnt(4)
  buffer_load_dwordx4 v[132:135], v1, s[44:47], s59 offen offset:3072 nt
  s_waitcnt vmcnt(4)
  buffer_load_dwordx4 v[136:139], v1, s[44:47], s59 offen offset:3200 nt
  s_waitcnt vmcnt(4)
  buffer_load_dwordx4 v[140:143], v1, s[44:47], s59 offen offset:3328 nt
  s_add_u32 s59, s59, 6144
  v_cvt_pk_bf16_f32 v50, v48, v49
  v_lshlrev_b32 v51, 16, v50
  v_and_b32 v52, s61, v50
  v_mul_f32 v51, s60, v51
  v_mul_f32 v52, s60, v52
  v_max3_f32 v56, v56, v51, v52
  v_cvt_pk_bf16_f32 v46, v51, v52
  s_waitcnt vmcnt(18)
  v_mov_b32 v48, 0
  v_mov_b32 v49, 0
  v_dot2c_f32_bf16 v48, v144, v8
  v_dot2c_f32_bf16 v48, v145, v9
  v_dot2c_f32_bf16 v48, v146, v10
  v_dot2c_f32_bf16 v48, v147, v11
  v_dot2c_f32_bf16 v48, v148, v12
  v_dot2c_f32_bf16 v48, v149, v13
  v_dot2c_f32_bf16 v48, v150, v14
  v_dot2c_f32_bf16 v48, v151, v15
  v_dot2c_f32_bf16 v48, v152, v16
  v_dot2c_f32_bf16 v48, v153, v17
  v_dot2c_f32_bf16 v48, v154, v18
  v_dot2c_f32_bf16 v48, v155, v19
  v_dot2c_f32_bf16 v49, v156, v8
  v_dot2c_f32_bf16 v49, v157, v9
  v_dot2c_f32_bf16 v49, v158, v10
  v_dot2c_f32_bf16 v49, v159, v11
  v_dot2c_f32_bf16 v49, v160, v12
  v_dot2c_f32_bf16 v49, v161, v13
  v_dot2c_f32_bf16 v49, v162, v14
  v_dot2c_f32_bf16 v49, v163, v15
  v_dot2c_f32_bf16 v49, v164, v16
  v_dot2c_f32_bf16 v49, v165, v17
  v_dot2c_f32_bf16 v49, v166, v18
  v_dot2c_f32_bf16 v49, v167, v19
  v_add_f32_dpp v48, v48, v48 quad_perm:[1,0,3,2] row_mask:0xf bank_mask:0xf
  s_waitcnt vmcnt(4)
  buffer_load_dwordx4 v[144:147], v1, s[44:47], s59 offen offset:0 nt
  v_add_f32_dpp v49, v49, v49 quad_perm:[1,0,3,2] row_mask:0xf bank_mask:0xf
  v_add_f32_dpp v48, v48, v48 quad_perm:[2,3,0,1] row_mask:0xf bank_mask:0xf
  s_waitcnt vmcnt(4)
  v_add_f32_dpp v49, v49, v49 quad_perm:[2,3,0,1] row_mask:0xf bank_mask:0xf
  v_add_f32_dpp v48, v48, v48 row_half_mirror row_mask:0xf bank_mask:0xf
  buffer_load_dwordx4 v[148:151], v1, s[44:47], s59 offen offset:128 nt
  v_add_f32_dpp v49, v49, v49 row_half_mirror row_mask:0xf bank_mask:0xf
  s_waitcnt vmcnt(4)
  buffer_load_dwordx4 v[152:155], v1, s[44:47], s59 offen offset:256 nt
  s_waitcnt vmcnt(4)
  buffer_load_dwordx4 v[156:159], v1, s[44:47], s59 offen offset:3072 nt
  s_waitcnt vmcnt(4)
  buffer_load_dwordx4 v[160:163], v1, s[44:47], s59 offen offset:3200 nt
  s_waitcnt vmcnt(4)
  buffer_load_dwordx4 v[164:167], v1, s[44:47], s59 offen offset:3328 nt
  s_add_u32 s59, s59, 6144
  v_cvt_pk_bf16_f32 v50, v48, v49
  v_lshlrev_b32 v51, 16, v50
  v_and_b32 v52, s61, v50
  v_mul_f32 v51, s60, v51
  v_mul_f32 v52, s60, v52
  v_max3_f32 v56, v56, v51, v52
  v_cvt_pk_bf16_f32 v47, v51, v52
  s_nop 1
  v_max_f32_dpp v56, v56, v56 row_ror:8 row_mask:0xf bank_mask:0xf
  v_mov_b32 v48, v56
  s_nop 1
  v_permlane16_swap_b32 v56, v48
  v_max_f32 v56, v56, v48
  v_mov_b32 v48, v56
  s_nop 1
  v_permlane32_swap_b32 v56, v48
  v_max_f32 v56, v56, v48
  v_cvt_pk_bf16_f32 v48, v56, v56
  v_lshlrev_b32 v56, 16, v48
  v_mul_f32 v57, s62, v56
  v_sub_f32 v57, 0, v57
  v_mov_b32 v58, 0
  v_lshlrev_b32 v48, 16, v32
  v_and_b32 v49, s61, v32
  v_fma_f32 v48, v48, s62, v57
  v_fma_f32 v49, v49, s62, v57
  v_exp_f32 v48, v48
  v_exp_f32 v49, v49
  s_nop 0
  v_cvt_pk_bf16_f32 v50, v48, v48
  v_cvt_pk_bf16_f32 v51, v49, v49
  v_and_b32 v60, v50, v2
  v_and_b32 v61, v50, v3
  v_and_b32 v62, v50, v4
  v_and_b32 v63, v50, v5
  v_and_b32 v64, v51, v2
  v_and_b32 v65, v51, v3
  v_and_b32 v66, v51, v4
  v_and_b32 v67, v51, v5
  v_add_f32 v58, v58, v48
  v_add_f32 v58, v58, v49
  s_waitcnt vmcnt(18)
  v_mfma_f32_16x16x32_bf16 v[20:23], v[60:63], v[72:75], v[20:23]
  v_mfma_f32_16x16x32_bf16 v[24:27], v[60:63], v[76:79], v[24:27]
  v_mfma_f32_16x16x32_bf16 v[28:31], v[60:63], v[80:83], v[28:31]
  v_mfma_f32_16x16x32_bf16 v[20:23], v[64:67], v[84:87], v[20:23]
  v_mfma_f32_16x16x32_bf16 v[24:27], v[64:67], v[88:91], v[24:27]
  v_mfma_f32_16x16x32_bf16 v[28:31], v[64:67], v[92:95], v[28:31]
  s_waitcnt vmcnt(4)
  buffer_load_dwordx4 v[72:75], v1, s[44:47], s59 offen offset:0 nt
  s_waitcnt vmcnt(4)
  buffer_load_dwordx4 v[76:79], v1, s[44:47], s59 offen offset:128 nt
  s_waitcnt vmcnt(4)
  buffer_load_dwordx4 v[80:83], v1, s[44:47], s59 offen offset:256 nt
  s_waitcnt vmcnt(4)
  buffer_load_dwordx4 v[84:87], v1, s[44:47], s59 offen offset:3072 nt
  s_waitcnt vmcnt(4)
  buffer_load_dwordx4 v[88:91], v1, s[44:47], s59 offen offset:3200 nt
  s_waitcnt vmcnt(4)
  buffer_load_dwordx4 v[92:95], v1, s[44:47], s59 offen offset:3328 nt
  s_add_u32 s59, s59, 6144
  v_lshlrev_b32 v48, 16, v33
  v_and_b32 v49, s61, v33
  v_fma_f32 v48, v48, s62, v57
  v_fma_f32 v49, v49, s62, v57
  v_exp_f32 v48, v48
  v_exp_f32 v49, v49
  s_nop 0
  v_cvt_pk_bf16_f32 v50, v48, v48
  v_cvt_pk_bf16_f32 v51, v49, v49
  v_and_b32 v60, v50, v2
  v_and_b32 v61, v50, v3
  v_and_b32 v62, v50, v4
  v_and_b32 v63, v50, v5
  v_and_b32 v64, v51, v2
  v_and_b32 v65, v51, v3
  v_and_b32 v66, v51, v4
  v_and_b32 v67, v51, v5
  v_add_f32 v58, v58, v48
  v_add_f32 v58, v58, v49
  s_waitcnt vmcnt(18)
  v_mfma_f32_16x16x32_bf16 v[20:23], v[60:63], v[96:99], v[20:23]
  v_mfma_f32_16x16x32_bf16 v[24:27], v[60:63], v[100:103], v[24:27]
  v_mfma_f32_16x16x32_bf16 v[28:31], v[60:63], v[104:107], v[28:31]
  v_mfma_f32_16x16x32_bf16 v[20:23], v[64:67], v[108:111], v[20:23]
  v_mfma_f32_16x16x32_bf16 v[24:27], v[64:67], v[112:115], v[24:27]
  v_mfma_f32_16x16x32_bf16 v[28:31], v[64:67], v[116:119], v[28:31]
  s_waitcnt vmcnt(4)
  buffer_load_dwordx4 v[96:99], v1, s[44:47], s59 offen offset:0 nt
  s_waitcnt vmcnt(4)
  buffer_load_dwordx4 v[100:103], v1, s[44:47], s59 offen offset:128 nt
  s_waitcnt vmcnt(4)
  buffer_load_dwordx4 v[104:107], v1, s[44:47], s59 offen offset:256 nt
  s_waitcnt vmcnt(4)
  buffer_load_dwordx4 v[108:111], v1, s[44:47], s59 offen offset:3072 nt
  s_waitcnt vmcnt(4)
  buffer_load_dwordx4 v[112:115], v1, s[44:47], s59 offen offset:3200 nt
  s_waitcnt vmcnt(4)
  buffer_load_dwordx4 v[116:119], v1, s[44:47], s59 offen offset:3328 nt
  s_add_u32 s59, s59, 6144
  v_lshlrev_b32 v48, 16, v34
  v_and_b32 v49, s61, v34
  v_fma_f32 v48, v48, s62, v57
  v_fma_f32 v49, v49, s62, v57
  v_exp_f32 v48, v48
  v_exp_f32 v49, v49
  s_nop 0
  v_cvt_pk_bf16_f32 v50, v48, v48
  v_cvt_pk_bf16_f32 v51, v49, v49
  v_and_b32 v60, v50, v2
  v_and_b32 v61, v50, v3
  v_and_b32 v62, v50, v4
  v_and_b32 v63, v50, v5
  v_and_b32 v64, v51, v2
  v_and_b32 v65, v51, v3
  v_and_b32 v66, v51, v4
  v_and_b32 v67, v51, v5
  v_add_f32 v58, v58, v48
  v_add_f32 v58, v58, v49
  s_waitcnt vmcnt(18)
  v_mfma_f32_16x16x32_bf16 v[20:23], v[60:63], v[120:123], v[20:23]
  v_mfma_f32_16x16x32_bf16 v[24:27], v[60:63], v[124:127], v[24:27]
  v_mfma_f32_16x16x32_bf16 v[28:31], v[60:63], v[128:131], v[28:31]
  v_mfma_f32_16x16x32_bf16 v[20:23], v[64:67], v[132:135], v[20:23]
  v_mfma_f32_16x16x32_bf16 v[24:27], v[64:67], v[136:139], v[24:27]
  v_mfma_f32_16x16x32_bf16 v[28:31], v[64:67], v[140:143], v[28:31]
  s_waitcnt vmcnt(4)
  buffer_load_dwordx4 v[120:123], v1, s[44:47], s59 offen offset:0 nt
  s_waitcnt vmcnt(4)
  buffer_load_dwordx4 v[124:127], v1, s[44:47], s59 offen offset:128 nt
  s_waitcnt vmcnt(4)
  buffer_load_dwordx4 v[128:131], v1, s[44:47], s59 offen offset:256 nt
  s_waitcnt vmcnt(4)
  buffer_load_dwordx4 v[132:135], v1, s[44:47], s59 offen offset:3072 nt
  s_waitcnt vmcnt(4)
  buffer_load_dwordx4 v[136:139], v1, s[44:47], s59 offen offset:3200 nt
  s_waitcnt vmcnt(4)
  buffer_load_dwordx4 v[140:143], v1, s[44:47], s59 offen offset:3328 nt
  s_add_u32 s59, s59, 6144
  v_lshlrev_b32 v48, 16, v35
  v_and_b32 v49, s61, v35
  v_fma_f32 v48, v48, s62, v57
  v_fma_f32 v49, v49, s62, v57
  v_exp_f32 v48, v48
  v_exp_f32 v49, v49
  s_nop 0
  v_cvt_pk_bf16_f32 v50, v48, v48
  v_cvt_pk_bf16_f32 v51, v49, v49
  v_and_b32 v60, v50, v2
  v_and_b32 v61, v50, v3
  v_and_b32 v62, v50, v4
  v_and_b32 v63, v50, v5
  v_and_b32 v64, v51, v2
  v_and_b32 v65, v51, v3
  v_and_b32 v66, v51, v4
  v_and_b32 v67, v51, v5
  v_add_f32 v58, v58, v48
  v_add_f32 v58, v58, v49
  s_waitcnt vmcnt(18)
  v_mfma_f32_16x16x32_bf16 v[20:23], v[60:63], v[144:147], v[20:23]
  v_mfma_f32_16x16x32_bf16 v[24:27], v[60:63], v[148:151], v[24:27]
  v_mfma_f32_16x16x32_bf16 v[28:31], v[60:63], v[152:155], v[28:31]
  v_mfma_f32_16x16x32_bf16 v[20:23], v[64:67], v[156:159], v[20:23]
  v_mfma_f32_16x16x32_bf16 v[24:27], v[64:67], v[160:163], v[24:27]
  v_mfma_f32_16x16x32_bf16 v[28:31], v[64:67], v[164:167], v[28:31]
  s_waitcnt vmcnt(4)
  buffer_load_dwordx4 v[144:147], v1, s[44:47], s59 offen offset:0 nt
  s_waitcnt vmcnt(4)
  buffer_load_dwordx4 v[148:151], v1, s[44:47], s59 offen offset:128 nt
  s_waitcnt vmcnt(4)
  buffer_load_dwordx4 v[152:155], v1, s[44:47], s59 offen offset:256 nt
  s_waitcnt vmcnt(4)
  buffer_load_dwordx4 v[156:159], v1, s[44:47], s59 offen offset:3072 nt
  s_waitcnt vmcnt(4)
  buffer_load_dwordx4 v[160:163], v1, s[44:47], s59 offen offset:3200 nt
  s_waitcnt vmcnt(4)
  buffer_load_dwordx4 v[164:167], v1, s[44:47], s59 offen offset:3328 nt
  s_add_u32 s59, s59, 6144
  v_lshlrev_b32 v48, 16, v36
  v_and_b32 v49, s61, v36
  v_fma_f32 v48, v48, s62, v57
  v_fma_f32 v49, v49, s62, v57
  v_exp_f32 v48, v48
  v_exp_f32 v49, v49
  s_nop 0
  v_cvt_pk_bf16_f32 v50, v48, v48
  v_cvt_pk_bf16_f32 v51, v49, v49
  v_and_b32 v60, v50, v2
  v_and_b32 v61, v50, v3
  v_and_b32 v62, v50, v4
  v_and_b32 v63, v50, v5
  v_and_b32 v64, v51, v2
  v_and_b32 v65, v51, v3
  v_and_b32 v66, v51, v4
  v_and_b32 v67, v51, v5
  v_add_f32 v58, v58, v48
  v_add_f32 v58, v58, v49
  s_waitcnt vmcnt(18)
  v_mfma_f32_16x16x32_bf16 v[20:23], v[60:63], v[72:75], v[20:23]
  v_mfma_f32_16x16x32_bf16 v[24:27], v[60:63], v[76:79], v[24:27]
  v_mfma_f32_16x16x32_bf16 v[28:31], v[60:63], v[80:83], v[28:31]
  v_mfma_f32_16x16x32_bf16 v[20:23], v[64:67], v[84:87], v[20:23]
  v_mfma_f32_16x16x32_bf16 v[24:27], v[64:67], v[88:91], v[24:27]
  v_mfma_f32_16x16x32_bf16 v[28:31], v[64:67], v[92:95], v[28:31]
  s_waitcnt vmcnt(4)
  buffer_load_dwordx4 v[72:75], v1, s[44:47], s59 offen offset:0 nt
  s_waitcnt vmcnt(4)
  buffer_load_dwordx4 v[76:79], v1, s[44:47], s59 offen offset:128 nt
  s_waitcnt vmcnt(4)
  buffer_load_dwordx4 v[80:83], v1, s[44:47], s59 offen offset:256 nt
  s_waitcnt vmcnt(4)
  buffer_load_dwordx4 v[84:87], v1, s[44:47], s59 offen offset:3072 nt
  s_waitcnt vmcnt(4)
  buffer_load_dwordx4 v[88:91], v1, s[44:47], s59 offen offset:3200 nt
  s_waitcnt vmcnt(4)
  buffer_load_dwordx4 v[92:95], v1, s[44:47], s59 offen offset:3328 nt
  s_add_u32 s59, s59, 6144
  v_lshlrev_b32 v48, 16, v37
  v_and_b32 v49, s61, v37
  v_fma_f32 v48, v48, s62, v57
  v_fma_f32 v49, v49, s62, v57
  v_exp_f32 v48, v48
  v_exp_f32 v49, v49
  s_nop 0
  v_cvt_pk_bf16_f32 v50, v48, v48
  v_cvt_pk_bf16_f32 v51, v49, v49
  v_and_b32 v60, v50, v2
  v_and_b32 v61, v50, v3
  v_and_b32 v62, v50, v4
  v_and_b32 v63, v50, v5
  v_and_b32 v64, v51, v2
  v_and_b32 v65, v51, v3
  v_and_b32 v66, v51, v4
  v_and_b32 v67, v51, v5
  v_add_f32 v58, v58, v48
  v_add_f32 v58, v58, v49
  s_waitcnt vmcnt(18)
  v_mfma_f32_16x16x32_bf16 v[20:23], v[60:63], v[96:99], v[20:23]
  v_mfma_f32_16x16x32_bf16 v[24:27], v[60:63], v[100:103], v[24:27]
  v_mfma_f32_16x16x32_bf16 v[28:31], v[60:63], v[104:107], v[28:31]
  v_mfma_f32_16x16x32_bf16 v[20:23], v[64:67], v[108:111], v[20:23]
  v_mfma_f32_16x16x32_bf16 v[24:27], v[64:67], v[112:115], v[24:27]
  v_mfma_f32_16x16x32_bf16 v[28:31], v[64:67], v[116:119], v[28:31]
  s_waitcnt vmcnt(4)
  buffer_load_dwordx4 v[96:99], v1, s[44:47], s59 offen offset:0 nt
  s_waitcnt vmcnt(4)
  buffer_load_dwordx4 v[100:103], v1, s[44:47], s59 offen offset:128 nt
  s_waitcnt vmcnt(4)
  buffer_load_dwordx4 v[104:107], v1, s[44:47], s59 offen offset:256 nt
  s_waitcnt vmcnt(4)
  buffer_load_dwordx4 v[108:111], v1, s[44:47], s59 offen offset:3072 nt
  s_waitcnt vmcnt(4)
  buffer_load_dwordx4 v[112:115], v1, s[44:47], s59 offen offset:3200 nt
  s_waitcnt vmcnt(4)
  buffer_load_dwordx4 v[116:119], v1, s[44:47], s59 offen offset:3328 nt
  s_add_u32 s59, s59, 6144
  v_lshlrev_b32 v48, 16, v38
  v_and_b32 v49, s61, v38
  v_fma_f32 v48, v48, s62, v57
  v_fma_f32 v49, v49, s62, v57
  v_exp_f32 v48, v48
  v_exp_f32 v49, v49
  s_nop 0
  v_cvt_pk_bf16_f32 v50, v48, v48
  v_cvt_pk_bf16_f32 v51, v49, v49
  v_and_b32 v60, v50, v2
  v_and_b32 v61, v50, v3
  v_and_b32 v62, v50, v4
  v_and_b32 v63, v50, v5
  v_and_b32 v64, v51, v2
  v_and_b32 v65, v51, v3
  v_and_b32 v66, v51, v4
  v_and_b32 v67, v51, v5
  v_add_f32 v58, v58, v48
  v_add_f32 v58, v58, v49
  s_waitcnt vmcnt(18)
  v_mfma_f32_16x16x32_bf16 v[20:23], v[60:63], v[120:123], v[20:23]
  v_mfma_f32_16x16x32_bf16 v[24:27], v[60:63], v[124:127], v[24:27]
  v_mfma_f32_16x16x32_bf16 v[28:31], v[60:63], v[128:131], v[28:31]
  v_mfma_f32_16x16x32_bf16 v[20:23], v[64:67], v[132:135], v[20:23]
  v_mfma_f32_16x16x32_bf16 v[24:27], v[64:67], v[136:139], v[24:27]
  v_mfma_f32_16x16x32_bf16 v[28:31], v[64:67], v[140:143], v[28:31]
  s_waitcnt vmcnt(4)
  buffer_load_dwordx4 v[120:123], v1, s[44:47], s59 offen offset:0 nt
  s_waitcnt vmcnt(4)
  buffer_load_dwordx4 v[124:127], v1, s[44:47], s59 offen offset:128 nt
  s_waitcnt vmcnt(4)
  buffer_load_dwordx4 v[128:131], v1, s[44:47], s59 offen offset:256 nt
  s_waitcnt vmcnt(4)
  buffer_load_dwordx4 v[132:135], v1, s[44:47], s59 offen offset:3072 nt
  s_waitcnt vmcnt(4)
  buffer_load_dwordx4 v[136:139], v1, s[44:47], s59 offen offset:3200 nt
  s_waitcnt vmcnt(4)
  buffer_load_dwordx4 v[140:143], v1, s[44:47], s59 offen offset:3328 nt
  s_add_u32 s59, s59, 6144
  v_lshlrev_b32 v48, 16, v39
  v_and_b32 v49, s61, v39
  v_fma_f32 v48, v48, s62, v57
  v_fma_f32 v49, v49, s62, v57
  v_exp_f32 v48, v48
  v_exp_f32 v49, v49
  s_nop 0
  v_cvt_pk_bf16_f32 v50, v48, v48
  v_cvt_pk_bf16_f32 v51, v49, v49
  v_and_b32 v60, v50, v2
  v_and_b32 v61, v50, v3
  v_and_b32 v62, v50, v4
  v_and_b32 v63, v50, v5
  v_and_b32 v64, v51, v2
  v_and_b32 v65, v51, v3
  v_and_b32 v66, v51, v4
  v_and_b32 v67, v51, v5
  v_add_f32 v58, v58, v48
  v_add_f32 v58, v58, v49
  s_waitcnt vmcnt(18)
  v_mfma_f32_16x16x32_bf16 v[20:23], v[60:63], v[144:147], v[20:23]
  v_mfma_f32_16x16x32_bf16 v[24:27], v[60:63], v[148:151], v[24:27]
  v_mfma_f32_16x16x32_bf16 v[28:31], v[60:63], v[152:155], v[28:31]
  v_mfma_f32_16x16x32_bf16 v[20:23], v[64:67], v[156:159], v[20:23]
  v_mfma_f32_16x16x32_bf16 v[24:27], v[64:67], v[160:163], v[24:27]
  v_mfma_f32_16x16x32_bf16 v[28:31], v[64:67], v[164:167], v[28:31]
  s_waitcnt vmcnt(4)
  buffer_load_dwordx4 v[144:147], v1, s[44:47], s59 offen offset:0 nt
  s_waitcnt vmcnt(4)
  buffer_load_dwordx4 v[148:151], v1, s[44:47], s59 offen offset:128 nt
  s_waitcnt vmcnt(4)
  buffer_load_dwordx4 v[152:155], v1, s[44:47], s59 offen offset:256 nt
  s_waitcnt vmcnt(4)
  buffer_load_dwordx4 v[156:159], v1, s[44:47], s59 offen offset:3072 nt
  s_waitcnt vmcnt(4)
  buffer_load_dwordx4 v[160:163], v1, s[44:47], s59 offen offset:3200 nt
  s_waitcnt vmcnt(4)
  buffer_load_dwordx4 v[164:167], v1, s[44:47], s59 offen offset:3328 nt
  s_add_u32 s59, s59, 6144
  v_lshlrev_b32 v48, 16, v40
  v_and_b32 v49, s61, v40
  v_fma_f32 v48, v48, s62, v57
  v_fma_f32 v49, v49, s62, v57
  v_exp_f32 v48, v48
  v_exp_f32 v49, v49
  s_nop 0
  v_cvt_pk_bf16_f32 v50, v48, v48
  v_cvt_pk_bf16_f32 v51, v49, v49
  v_and_b32 v60, v50, v2
  v_and_b32 v61, v50, v3
  v_and_b32 v62, v50, v4
  v_and_b32 v63, v50, v5
  v_and_b32 v64, v51, v2
  v_and_b32 v65, v51, v3
  v_and_b32 v66, v51, v4
  v_and_b32 v67, v51, v5
  v_add_f32 v58, v58, v48
  v_add_f32 v58, v58, v49
  s_waitcnt vmcnt(18)
  v_mfma_f32_16x16x32_bf16 v[20:23], v[60:63], v[72:75], v[20:23]
  v_mfma_f32_16x16x32_bf16 v[24:27], v[60:63], v[76:79], v[24:27]
  v_mfma_f32_16x16x32_bf16 v[28:31], v[60:63], v[80:83], v[28:31]
  v_mfma_f32_16x16x32_bf16 v[20:23], v[64:67], v[84:87], v[20:23]
  v_mfma_f32_16x16x32_bf16 v[24:27], v[64:67], v[88:91], v[24:27]
  v_mfma_f32_16x16x32_bf16 v[28:31], v[64:67], v[92:95], v[28:31]
  s_waitcnt vmcnt(7)
  buffer_load_dwordx4 v[72:75], v1, s[44:47], s59 offen offset:0 nt
  s_waitcnt vmcnt(7)
  buffer_load_dwordx4 v[76:79], v1, s[44:47], s59 offen offset:128 nt
  s_waitcnt vmcnt(7)
  buffer_load_dwordx4 v[80:83], v1, s[44:47], s59 offen offset:256 nt
  s_waitcnt vmcnt(7)
  buffer_load_dwordx4 v[84:87], v1, s[44:47], s59 offen offset:3072 nt
  s_waitcnt vmcnt(7)
  buffer_load_dwordx4 v[88:91], v1, s[44:47], s59 offen offset:3200 nt
  s_waitcnt vmcnt(7)
  buffer_load_dwordx4 v[92:95], v1, s[44:47], s59 offen offset:3328 nt
  s_add_u32 s59, s59, 6144
  v_lshlrev_b32 v48, 16, v41
  v_and_b32 v49, s61, v41
  v_fma_f32 v48, v48, s62, v57
  v_fma_f32 v49, v49, s62, v57
  v_exp_f32 v48, v48
  v_exp_f32 v49, v49
  s_nop 0
  v_cvt_pk_bf16_f32 v50, v48, v48
  v_cvt_pk_bf16_f32 v51, v49, v49
  v_and_b32 v60, v50, v2
  v_and_b32 v61, v50, v3
  v_and_b32 v62, v50, v4
  v_and_b32 v63, v50, v5
  v_and_b32 v64, v51, v2
  v_and_b32 v65, v51, v3
  v_and_b32 v66, v51, v4
  v_and_b32 v67, v51, v5
  v_add_f32 v58, v58, v48
  v_add_f32 v58, v58, v49
  s_waitcnt vmcnt(18)
  v_mfma_f32_16x16x32_bf16 v[20:23], v[60:63], v[96:99], v[20:23]
  v_mfma_f32_16x16x32_bf16 v[24:27], v[60:63], v[100:103], v[24:27]
  v_mfma_f32_16x16x32_bf16 v[28:31], v[60:63], v[104:107], v[28:31]
  v_mfma_f32_16x16x32_bf16 v[20:23], v[64:67], v[108:111], v[20:23]
  v_mfma_f32_16x16x32_bf16 v[24:27], v[64:67], v[112:115], v[24:27]
  v_mfma_f32_16x16x32_bf16 v[28:31], v[64:67], v[116:119], v[28:31]
  s_waitcnt vmcnt(7)
  buffer_load_dwordx4 v[96:99], v1, s[44:47], s59 offen offset:0 nt
  s_waitcnt vmcnt(7)
  buffer_load_dwordx4 v[100:103], v1, s[44:47], s59 offen offset:128 nt
  s_waitcnt vmcnt(7)
  buffer_load_dwordx4 v[104:107], v1, s[44:47], s59 offen offset:256 nt
  s_waitcnt vmcnt(7)
  buffer_load_dwordx4 v[108:111], v1, s[44:47], s59 offen offset:3072 nt
  s_waitcnt vmcnt(7)
  buffer_load_dwordx4 v[112:115], v1, s[44:47], s59 offen offset:3200 nt
  s_waitcnt vmcnt(7)
  buffer_load_dwordx4 v[116:119], v1, s[44:47], s59 offen offset:3328 nt
  s_add_u32 s59, s59, 6144
  v_lshlrev_b32 v48, 16, v42
  v_and_b32 v49, s61, v42
  v_fma_f32 v48, v48, s62, v57
  v_fma_f32 v49, v49, s62, v57
  v_exp_f32 v48, v48
  v_exp_f32 v49, v49
  s_nop 0
  v_cvt_pk_bf16_f32 v50, v48, v48
  v_cvt_pk_bf16_f32 v51, v49, v49
  v_and_b32 v60, v50, v2
  v_and_b32 v61, v50, v3
  v_and_b32 v62, v50, v4
  v_and_b32 v63, v50, v5
  v_and_b32 v64, v51, v2
  v_and_b32 v65, v51, v3
  v_and_b32 v66, v51, v4
  v_and_b32 v67, v51, v5
  v_add_f32 v58, v58, v48
  v_add_f32 v58, v58, v49
  s_waitcnt vmcnt(18)
  v_mfma_f32_16x16x32_bf16 v[20:23], v[60:63], v[120:123], v[20:23]
  v_mfma_f32_16x16x32_bf16 v[24:27], v[60:63], v[124:127], v[24:27]
  v_mfma_f32_16x16x32_bf16 v[28:31], v[60:63], v[128:131], v[28:31]
  v_mfma_f32_16x16x32_bf16 v[20:23], v[64:67], v[132:135], v[20:23]
  v_mfma_f32_16x16x32_bf16 v[24:27], v[64:67], v[136:139], v[24:27]
  v_mfma_f32_16x16x32_bf16 v[28:31], v[64:67], v[140:143], v[28:31]
  s_waitcnt vmcnt(7)
  buffer_load_dwordx4 v[120:123], v1, s[44:47], s59 offen offset:0 nt
  s_waitcnt vmcnt(7)
  buffer_load_dwordx4 v[124:127], v1, s[44:47], s59 offen offset:128 nt
  s_waitcnt vmcnt(7)
  buffer_load_dwordx4 v[128:131], v1, s[44:47], s59 offen offset:256 nt
  s_waitcnt vmcnt(7)
  buffer_load_dwordx4 v[132:135], v1, s[44:47], s59 offen offset:3072 nt
  s_waitcnt vmcnt(7)
  buffer_load_dwordx4 v[136:139], v1, s[44:47], s59 offen offset:3200 nt
  s_waitcnt vmcnt(7)
  buffer_load_dwordx4 v[140:143], v1, s[44:47], s59 offen offset:3328 nt
  s_add_u32 s59, s59, 6144
  v_lshlrev_b32 v48, 16, v43
  v_and_b32 v49, s61, v43
  v_fma_f32 v48, v48, s62, v57
  v_fma_f32 v49, v49, s62, v57
  v_exp_f32 v48, v48
  v_exp_f32 v49, v49
  s_nop 0
  v_cvt_pk_bf16_f32 v50, v48, v48
  v_cvt_pk_bf16_f32 v51, v49, v49
  v_and_b32 v60, v50, v2
  v_and_b32 v61, v50, v3
  v_and_b32 v62, v50, v4
  v_and_b32 v63, v50, v5
  v_and_b32 v64, v51, v2
  v_and_b32 v65, v51, v3
  v_and_b32 v66, v51, v4
  v_and_b32 v67, v51, v5
  v_add_f32 v58, v58, v48
  v_add_f32 v58, v58, v49
  s_waitcnt vmcnt(18)
  v_mfma_f32_16x16x32_bf16 v[20:23], v[60:63], v[144:147], v[20:23]
  v_mfma_f32_16x16x32_bf16 v[24:27], v[60:63], v[148:151], v[24:27]
  v_mfma_f32_16x16x32_bf16 v[28:31], v[60:63], v[152:155], v[28:31]
  v_mfma_f32_16x16x32_bf16 v[20:23], v[64:67], v[156:159], v[20:23]
  v_mfma_f32_16x16x32_bf16 v[24:27], v[64:67], v[160:163], v[24:27]
  v_mfma_f32_16x16x32_bf16 v[28:31], v[64:67], v[164:167], v[28:31]
  s_waitcnt vmcnt(7)
  buffer_load_dwordx4 v[144:147], v1, s[44:47], s59 offen offset:0 nt
  s_waitcnt vmcnt(7)
  buffer_load_dwordx4 v[148:151], v1, s[44:47], s59 offen offset:128 nt
  s_waitcnt vmcnt(7)
  buffer_load_dwordx4 v[152:155], v1, s[44:47], s59 offen offset:256 nt
  s_waitcnt vmcnt(7)
  buffer_load_dwordx4 v[156:159], v1, s[44:47], s59 offen offset:3072 nt
  s_waitcnt vmcnt(7)
  buffer_load_dwordx4 v[160:163], v1, s[44:47], s59 offen offset:3200 nt
  s_waitcnt vmcnt(7)
  buffer_load_dwordx4 v[164:167], v1, s[44:47], s59 offen offset:3328 nt
  s_add_u32 s59, s59, 6144
  s_mov_b64 exec, 1
  ds_add_u32 v240, v241 offset:4032
  s_mov_b64 exec, -1
  v_lshlrev_b32 v48, 16, v44
  v_and_b32 v49, s61, v44
  v_fma_f32 v48, v48, s62, v57
  v_fma_f32 v49, v49, s62, v57
  v_exp_f32 v48, v48
  v_exp_f32 v49, v49
  s_nop 0
  v_cvt_pk_bf16_f32 v50, v48, v48
  v_cvt_pk_bf16_f32 v51, v49, v49
  v_and_b32 v60, v50, v2
  v_and_b32 v61, v50, v3
  v_and_b32 v62, v50, v4
  v_and_b32 v63, v50, v5
  v_and_b32 v64, v51, v2
  v_and_b32 v65, v51, v3
  v_and_b32 v66, v51, v4
  v_and_b32 v67, v51, v5
  v_add_f32 v58, v58, v48
  v_add_f32 v58, v58, v49
  s_waitcnt vmcnt(18)
  v_mfma_f32_16x16x32_bf16 v[20:23], v[60:63], v[72:75], v[20:23]
  v_mfma_f32_16x16x32_bf16 v[24:27], v[60:63], v[76:79], v[24:27]
  v_mfma_f32_16x16x32_bf16 v[28:31], v[60:63], v[80:83], v[28:31]
  v_mfma_f32_16x16x32_bf16 v[20:23], v[64:67], v[84:87], v[20:23]
  v_mfma_f32_16x16x32_bf16 v[24:27], v[64:67], v[88:91], v[24:27]
  v_mfma_f32_16x16x32_bf16 v[28:31], v[64:67], v[92:95], v[28:31]
  v_lshlrev_b32 v48, 16, v45
  v_and_b32 v49, s61, v45
  v_fma_f32 v48, v48, s62, v57
  v_fma_f32 v49, v49, s62, v57
  v_exp_f32 v48, v48
  v_exp_f32 v49, v49
  s_nop 0
  v_cvt_pk_bf16_f32 v50, v48, v48
  v_cvt_pk_bf16_f32 v51, v49, v49
  v_and_b32 v60, v50, v2
  v_and_b32 v61, v50, v3
  v_and_b32 v62, v50, v4
  v_and_b32 v63, v50, v5
  v_and_b32 v64, v51, v2
  v_and_b32 v65, v51, v3
  v_and_b32 v66, v51, v4
  v_and_b32 v67, v51, v5
  v_add_f32 v58, v58, v48
  v_add_f32 v58, v58, v49
  s_waitcnt vmcnt(12)
  v_mfma_f32_16x16x32_bf16 v[20:23], v[60:63], v[96:99], v[20:23]
  v_mfma_f32_16x16x32_bf16 v[24:27], v[60:63], v[100:103], v[24:27]
  v_mfma_f32_16x16x32_bf16 v[28:31], v[60:63], v[104:107], v[28:31]
  v_mfma_f32_16x16x32_bf16 v[20:23], v[64:67], v[108:111], v[20:23]
  v_mfma_f32_16x16x32_bf16 v[24:27], v[64:67], v[112:115], v[24:27]
  v_mfma_f32_16x16x32_bf16 v[28:31], v[64:67], v[116:119], v[28:31]
  v_lshlrev_b32 v48, 16, v46
  v_and_b32 v49, s61, v46
  v_fma_f32 v48, v48, s62, v57
  v_fma_f32 v49, v49, s62, v57
  v_exp_f32 v48, v48
  v_exp_f32 v49, v49
  s_nop 0
  v_cvt_pk_bf16_f32 v50, v48, v48
  v_cvt_pk_bf16_f32 v51, v49, v49
  v_and_b32 v60, v50, v2
  v_and_b32 v61, v50, v3
  v_and_b32 v62, v50, v4
  v_and_b32 v63, v50, v5
  v_and_b32 v64, v51, v2
  v_and_b32 v65, v51, v3
  v_and_b32 v66, v51, v4
  v_and_b32 v67, v51, v5
  v_add_f32 v58, v58, v48
  v_add_f32 v58, v58, v49
  s_waitcnt vmcnt(6)
  v_mfma_f32_16x16x32_bf16 v[20:23], v[60:63], v[120:123], v[20:23]
  v_mfma_f32_16x16x32_bf16 v[24:27], v[60:63], v[124:127], v[24:27]
  v_mfma_f32_16x16x32_bf16 v[28:31], v[60:63], v[128:131], v[28:31]
  v_mfma_f32_16x16x32_bf16 v[20:23], v[64:67], v[132:135], v[20:23]
  v_mfma_f32_16x16x32_bf16 v[24:27], v[64:67], v[136:139], v[24:27]
  v_mfma_f32_16x16x32_bf16 v[28:31], v[64:67], v[140:143], v[28:31]
  v_lshlrev_b32 v48, 16, v47
  v_and_b32 v49, s61, v47
  v_fma_f32 v48, v48, s62, v57
  v_fma_f32 v49, v49, s62, v57
  v_exp_f32 v48, v48
  v_exp_f32 v49, v49
  s_nop 0
  v_cvt_pk_bf16_f32 v50, v48, v48
  v_cvt_pk_bf16_f32 v51, v49, v49
  v_and_b32 v60, v50, v2
  v_and_b32 v61, v50, v3
  v_and_b32 v62, v50, v4
  v_and_b32 v63, v50, v5
  v_and_b32 v64, v51, v2
  v_and_b32 v65, v51, v3
  v_and_b32 v66, v51, v4
  v_and_b32 v67, v51, v5
  v_add_f32 v58, v58, v48
  v_add_f32 v58, v58, v49
  s_waitcnt vmcnt(0)
  v_mfma_f32_16x16x32_bf16 v[20:23], v[60:63], v[144:147], v[20:23]
  v_mfma_f32_16x16x32_bf16 v[24:27], v[60:63], v[148:151], v[24:27]
  v_mfma_f32_16x16x32_bf16 v[28:31], v[60:63], v[152:155], v[28:31]
  v_mfma_f32_16x16x32_bf16 v[20:23], v[64:67], v[156:159], v[20:23]
  v_mfma_f32_16x16x32_bf16 v[24:27], v[64:67], v[160:163], v[24:27]
  v_mfma_f32_16x16x32_bf16 v[28:31], v[64:67], v[164:167], v[28:31]
  s_nop 1
  v_add_f32_dpp v58, v58, v58 row_ror:8 row_mask:0xf bank_mask:0xf
  v_mov_b32 v48, v58
  s_nop 1
  v_permlane16_swap_b32 v58, v48
  v_add_f32 v58, v58, v48
  v_mov_b32 v48, v58
  s_nop 1
  v_permlane32_swap_b32 v58, v48
  v_add_f32 v58, v58, v48
  s_mov_b32 exec_lo, 0x00ff00ff
  s_mov_b32 exec_hi, 0xff00ff00
  ds_write_b128 v243, v[20:23] offset:4096
  ds_write_b128 v243, v[24:27] offset:4352
  ds_write_b128 v243, v[28:31] offset:4608
  s_mov_b64 exec, 1
  ds_write_b32 v244, v56 offset:3968
  ds_write_b32 v244, v58 offset:3984
  s_waitcnt lgkmcnt(0)
  ds_add_u32 v240, v241 offset:4036
  s_mov_b64 exec, -1
  s_branch L_tail
L_aux:
  s_sub_u32 s38, s28, 4
  s_mov_b32 s40, s4
  s_and_b32 s41, s5, 0xffff
  s_mov_b32 s42, 2560
  s_mov_b32 s43, 0x20000
  v_lshrrev_b32 v1, 5, v0
  v_and_b32 v2, 31, v0
  v_mul_u32_u24 v3, 1280, v1
  v_mul_u32_u24 v4, 40, v2
  v_add_u32 v3, v3, v4
  buffer_load_dwordx4 v[8:11], v3, s[40:43], 0 offen
  buffer_load_dwordx4 v[12:15], v3, s[40:43], 0 offen offset:16
  buffer_load_dwordx2 v[16:17], v3, s[40:43], 0 offen offset:32
  s_cmp_eq_u32 s38, 3
  s_cbranch_scc1 L_aux_ffn_ld
  s_mov_b32 s44, s10
  s_and_b32 s45, s11, 0xffff
  s_mov_b32 s46, 7864320
  s_mov_b32 s47, 0x20000
  v_lshrrev_b32 v4, 3, v0
  v_mul_u32_u24 v4, 12288, v4
  v_and_b32 v5, 7, v0
  v_lshlrev_b32 v5, 4, v5
  v_add_u32 v4, v4, v5
  s_mul_i32 s56, s31, 983040
  s_mul_i32 s57, s35, 384
  s_add_u32 s56, s56, s57
  s_lshl_b32 s57, s38, 7
  s_add_u32 s56, s56, s57
  s_mul_i32 s57, s38, 10240
  s_add_u32 s57, s57, 10240
  s_mov_b32 m0, s57
  s_add_u32 s57, s57, 1024
  buffer_load_dwordx4 v4, s[44:47], s56 offen nt lds
  s_add_u32 s56, s56, 98304
  s_mov_b32 m0, s57
  s_add_u32 s57, s57, 1024
  buffer_load_dwordx4 v4, s[44:47], s56 offen nt lds
  s_add_u32 s56, s56, 98304
  s_mov_b32 m0, s57
  s_add_u32 s57, s57, 1024
  buffer_load_dwordx4 v4, s[44:47], s56 offen nt lds
  s_add_u32 s56, s56, 98304
  s_mov_b32 m0, s57
  s_add_u32 s57, s57, 1024
  buffer_load_dwordx4 v4, s[44:47], s56 offen nt lds
  s_add_u32 s56, s56, 98304
  s_mov_b32 m0, s57
  s_add_u32 s57, s57, 1024
  buffer_load_dwordx4 v4, s[44:47], s56 offen nt lds
  s_add_u32 s56, s56, 98304
  s_mov_b32 m0, s57
  s_add_u32 s57, s57, 1024
  buffer_load_dwordx4 v4, s[44:47], s56 offen nt lds
  s_add_u32 s56, s56, 98304
  s_mov_b32 m0, s57
  s_add_u32 s57, s57, 1024
  buffer_load_dwordx4 v4, s[44:47], s56 offen nt lds
  s_add_u32 s56, s56, 98304
  s_mov_b32 m0, s57
  s_add_u32 s57, s57, 1024
  buffer_load_dwordx4 v4, s[44:47], s56 offen nt lds
  s_add_u32 s56, s56, 98304
  s_mov_b32 m0, s57
  s_add_u32 s57, s57, 1024
  buffer_load_dwordx4 v4, s[44:47], s56 offen nt lds
  s_add_u32 s56, s56, 98304
  s_mov_b32 m0, s57
  s_add_u32 s57, s57, 1024
  buffer_load_dwordx4 v4, s[44:47], s56 offen nt lds
  s_add_u32 s56, s56, 98304
  s_barrier
  s_waitcnt vmcnt(10)
  s_branch L_aux_ln
L_aux_ffn_ld:
  s_cmp_ge_u32 s34, 16
  s_cselect_b32 s56, s18, s16
  s_cselect_b32 s57, s19, s17
  s_mov_b32 s44, s56
  s_and_b32 s45, s57, 0xffff
  s_mov_b32 s46, 1966080
  s_mov_b32 s47, 0x20000
  s_barrier
  s_waitcnt vmcnt(0)
L_aux_ln:
  v_lshlrev_b32 v20, 16, v8
  v_and_b32 v21, 0xffff0000, v8
  v_lshlrev_b32 v22, 16, v9
  v_and_b32 v23, 0xffff0000, v9
  v_lshlrev_b32 v24, 16, v10
  v_and_b32 v25, 0xffff0000, v10
  v_lshlrev_b32 v26, 16, v11
  v_and_b32 v27, 0xffff0000, v11
  v_lshlrev_b32 v28, 16, v12
  v_and_b32 v29, 0xffff0000, v12
  v_lshlrev_b32 v30, 16, v13
  v_and_b32 v31, 0xffff0000, v13
  v_lshlrev_b32 v32, 16, v14
  v_and_b32 v33, 0xffff0000, v14
  v_lshlrev_b32 v34, 16, v15
  v_and_b32 v35, 0xffff0000, v15
  v_lshlrev_b32 v36, 16, v16
  v_and_b32 v37, 0xffff0000, v16
  v_lshlrev_b32 v38, 16, v17
  v_and_b32 v39, 0xffff0000, v17
  v_add_f32 v44, v20, v21
  v_add_f32 v45, v22, v23
  v_add_f32 v44, v44, v24
  v_add_f32 v44, v44, v25
  v_add_f32 v45, v45, v26
  v_add_f32 v45, v45, v27
  v_add_f32 v44, v44, v28
  v_add_f32 v44, v44, v29
  v_add_f32 v45, v45, v30
  v_add_f32 v45, v45, v31
  v_add_f32 v44, v44, v32
  v_add_f32 v44, v44, v33
  v_add_f32 v45, v45, v34
  v_add_f32 v45, v45, v35
  v_add_f32 v44, v44, v36
  v_add_f32 v44, v44, v37
  v_add_f32 v45, v45, v38
  v_add_f32 v45, v45, v39
  v_add_f32 v44, v44, v45
  s_nop 1
  v_add_f32_dpp v44, v44, v44 quad_perm:[1,0,3,2] row_mask:0xf bank_mask:0xf
  s_nop 1
  v_add_f32_dpp v44, v44, v44 quad_perm:[2,3,0,1] row_mask:0xf bank_mask:0xf
  s_nop 1
  v_add_f32_dpp v44, v44, v44 row_half_mirror row_mask:0xf bank_mask:0xf
  s_nop 1
  v_add_f32_dpp v44, v44, v44 row_mirror row_mask:0xf bank_mask:0xf
  v_mov_b32 v47, v44
  s_nop 1
  v_permlane16_swap_b32 v44, v47
  v_add_f32 v44, v44, v47
  s_mov_b32 s56, 986500301
  v_mul_f32 v44, s56, v44
  v_mov_b32 v45, 0
  v_mov_b32 v46, 0
  v_sub_f32 v48, v20, v44
  v_fmac_f32 v45, v48, v48
  v_sub_f32 v48, v21, v44
  v_fmac_f32 v46, v48, v48
  v_sub_f32 v48, v22, v44
  v_fmac_f32 v45, v48, v48
  v_sub_f32 v48, v23, v44
  v_fmac_f32 v46, v48, v48
  v_sub_f32 v48, v24, v44
  v_fmac_f32 v45, v48, v48
  v_sub_f32 v48, v25, v44
  v_fmac_f32 v46, v48, v48
  v_sub_f32 v48, v26, v44
  v_fmac_f32 v45, v48, v48
  v_sub_f32 v48, v27, v44
  v_fmac_f32 v46, v48, v48
  v_sub_f32 v48, v28, v44
  v_fmac_f32 v45, v48, v48
  v_sub_f32 v48, v29, v44
  v_fmac_f32 v46, v48, v48
  v_sub_f32 v48, v30, v44
  v_fmac_f32 v45, v48, v48
  v_sub_f32 v48, v31, v44
  v_fmac_f32 v46, v48, v48
  v_sub_f32 v48, v32, v44
  v_fmac_f32 v45, v48, v48
  v_sub_f32 v48, v33, v44
  v_fmac_f32 v46, v48, v48
  v_sub_f32 v48, v34, v44
  v_fmac_f32 v45, v48, v48
  v_sub_f32 v48, v35, v44
  v_fmac_f32 v46, v48, v48
  v_sub_f32 v48, v36, v44
  v_fmac_f32 v45, v48, v48
  v_sub_f32 v48, v37, v44
  v_fmac_f32 v46, v48, v48
  v_sub_f32 v48, v38, v44
  v_fmac_f32 v45, v48, v48
  v_sub_f32 v48, v39, v44
  v_fmac_f32 v46, v48, v48
  v_add_f32 v45, v45, v46
  s_nop 1
  v_add_f32_dpp v45, v45, v45 quad_perm:[1,0,3,2] row_mask:0xf bank_mask:0xf
  s_nop 1
  v_add_f32_dpp v45, v45, v45 quad_perm:[2,3,0,1] row_mask:0xf bank_mask:0xf
  s_nop 1
  v_add_f32_dpp v45, v45, v45 row_half_mirror row_mask:0xf bank_mask:0xf
  s_nop 1
  v_add_f32_dpp v45, v45, v45 row_mirror row_mask:0xf bank_mask:0xf
  v_mov_b32 v47, v45
  s_nop 1
  v_permlane16_swap_b32 v45, v47
  v_add_f32 v45, v45, v47
  v_mul_f32 v45, s56, v45
  v_cvt_pk_bf16_f32 v46, v44, v45
  v_lshlrev_b32 v44, 16, v46
  v_and_b32 v45, 0xffff0000, v46
  v_add_f32 v45, 925368320, v45
  v_cvt_pk_bf16_f32 v45, v45, v45
  v_and_b32 v45, 0xffff0000, v45
  v_sqrt_f32 v45, v45
  s_nop 0
  v_cvt_pk_bf16_f32 v45, v45, v45
  v_and_b32 v45, 0xffff0000, v45
  v_rcp_f32 v45, v45
  v_sub_f32 v48, v20, v44
  v_sub_f32 v49, v21, v44
  v_cvt_pk_bf16_f32 v48, v48, v49
  v_and_b32 v49, 0xffff0000, v48
  v_lshlrev_b32 v48, 16, v48
  v_mul_f32 v48, v48, v45
  v_mul_f32 v49, v49, v45
  v_cvt_pk_bf16_f32 v8, v48, v49
  v_sub_f32 v48, v22, v44
  v_sub_f32 v49, v23, v44
  v_cvt_pk_bf16_f32 v48, v48, v49
  v_and_b32 v49, 0xffff0000, v48
  v_lshlrev_b32 v48, 16, v48
  v_mul_f32 v48, v48, v45
  v_mul_f32 v49, v49, v45
  v_cvt_pk_bf16_f32 v9, v48, v49
  v_sub_f32 v48, v24, v44
  v_sub_f32 v49, v25, v44
  v_cvt_pk_bf16_f32 v48, v48, v49
  v_and_b32 v49, 0xffff0000, v48
  v_lshlrev_b32 v48, 16, v48
  v_mul_f32 v48, v48, v45
  v_mul_f32 v49, v49, v45
  v_cvt_pk_bf16_f32 v10, v48, v49
  v_sub_f32 v48, v26, v44
  v_sub_f32 v49, v27, v44
  v_cvt_pk_bf16_f32 v48, v48, v49
  v_and_b32 v49, 0xffff0000, v48
  v_lshlrev_b32 v48, 16, v48
  v_mul_f32 v48, v48, v45
  v_mul_f32 v49, v49, v45
  v_cvt_pk_bf16_f32 v11, v48, v49
  v_sub_f32 v48, v28, v44
  v_sub_f32 v49, v29, v44
  v_cvt_pk_bf16_f32 v48, v48, v49
  v_and_b32 v49, 0xffff0000, v48
  v_lshlrev_b32 v48, 16, v48
  v_mul_f32 v48, v48, v45
  v_mul_f32 v49, v49, v45
  v_cvt_pk_bf16_f32 v12, v48, v49
  v_sub_f32 v48, v30, v44
  v_sub_f32 v49, v31, v44
  v_cvt_pk_bf16_f32 v48, v48, v49
  v_and_b32 v49, 0xffff0000, v48
  v_lshlrev_b32 v48, 16, v48
  v_mul_f32 v48, v48, v45
  v_mul_f32 v49, v49, v45
  v_cvt_pk_bf16_f32 v13, v48, v49
  v_sub_f32 v48, v32, v44
  v_sub_f32 v49, v33, v44
  v_cvt_pk_bf16_f32 v48, v48, v49
  v_and_b32 v49, 0xffff0000, v48
  v_lshlrev_b32 v48, 16, v48
  v_mul_f32 v48, v48, v45
  v_mul_f32 v49, v49, v45
  v_cvt_pk_bf16_f32 v14, v48, v49
  v_sub_f32 v48, v34, v44
  v_sub_f32 v49, v35, v44
  v_cvt_pk_bf16_f32 v48, v48, v49
  v_and_b32 v49, 0xffff0000, v48
  v_lshlrev_b32 v48, 16, v48
  v_mul_f32 v48, v48, v45
  v_mul_f32 v49, v49, v45
  v_cvt_pk_bf16_f32 v15, v48, v49
  v_sub_f32 v48, v36, v44
  v_sub_f32 v49, v37, v44
  v_cvt_pk_bf16_f32 v48, v48, v49
  v_and_b32 v49, 0xffff0000, v48
  v_lshlrev_b32 v48, 16, v48
  v_mul_f32 v48, v48, v45
  v_mul_f32 v49, v49, v45
  v_cvt_pk_bf16_f32 v16, v48, v49
  v_sub_f32 v48, v38, v44
  v_sub_f32 v49, v39, v44
  v_cvt_pk_bf16_f32 v48, v48, v49
  v_and_b32 v49, 0xffff0000, v48
  v_lshlrev_b32 v48, 16, v48
  v_mul_f32 v48, v48, v45
  v_mul_f32 v49, v49, v45
  v_cvt_pk_bf16_f32 v17, v48, v49
  ds_write_b64 v3, v[8:9] offset:0
  ds_write_b64 v3, v[10:11] offset:8
  ds_write_b64 v3, v[12:13] offset:16
  ds_write_b64 v3, v[14:15] offset:24
  ds_write_b64 v3, v[16:17] offset:32
  v_and_b32 v4, 15, v0
  v_lshrrev_b32 v5, 4, v0
  v_and_b32 v6, 1, v0
  v_mul_u32_u24 v6, 1280, v6
  v_lshlrev_b32 v7, 4, v5
  v_add_u32 v6, v6, v7
  v_lshlrev_b32 v50, 3, v5
  v_lshrrev_b32 v51, 2, v4
  v_add_u32 v50, v50, v51
  v_and_b32 v51, 3, v4
  v_lshlrev_b32 v51, 3, v51
  s_waitcnt lgkmcnt(0)
  s_cmp_eq_u32 s38, 3
  s_cbranch_scc1 L_aux_ffn
  s_mul_i32 s56, s31, 160
  v_add_u32 v6, s56, v6
  ds_read_b128 v[8:11], v6 offset:0
  ds_read_b128 v[12:15], v6 offset:64
  ds_read_b128 v[16:19], v6 offset:128
  s_mul_i32 s56, s38, 10240
  s_add_u32 s56, s56, 10240
  v_lshlrev_b32 v52, 7, v50
  v_add3_u32 v52, v52, v51, s56
  v_cmp_le_u32 vcc, 2, v5
  v_subrev_u32 v53, 2048, v52
  s_nop 0
  v_cndmask_b32 v53, v52, v53, vcc
  v_mov_b32 v24, 0
  v_mov_b32 v25, 0
  v_mov_b32 v26, 0
  v_mov_b32 v27, 0
  v_mov_b32 v28, 0
  v_mov_b32 v29, 0
  v_mov_b32 v30, 0
  v_mov_b32 v31, 0
  v_mov_b32 v32, 0
  v_mov_b32 v33, 0
  v_mov_b32 v34, 0
  v_mov_b32 v35, 0
  v_mov_b32 v36, 0
  v_mov_b32 v37, 0
  v_mov_b32 v38, 0
  v_mov_b32 v39, 0
  s_waitcnt lgkmcnt(0)
  v_cndmask_b32 v16, v16, 0, vcc
  v_cndmask_b32 v17, v17, 0, vcc
  v_cndmask_b32 v18, v18, 0, vcc
  v_cndmask_b32 v19, v19, 0, vcc
  s_waitcnt vmcnt(0)
  ds_read_b64_tr_b16 v[56:57], v52 offset:0
  ds_read_b64_tr_b16 v[58:59], v52 offset:512
  ds_read_b64_tr_b16 v[60:61], v52 offset:32
  ds_read_b64_tr_b16 v[62:63], v52 offset:544
  ds_read_b64_tr_b16 v[64:65], v52 offset:64
  ds_read_b64_tr_b16 v[66:67], v52 offset:576
  ds_read_b64_tr_b16 v[68:69], v52 offset:96
  ds_read_b64_tr_b16 v[70:71], v52 offset:608
  s_waitcnt lgkmcnt(0)
  v_mfma_f32_16x16x32_bf16 v[24:27], v[56:59], v[8:11], v[24:27]
  v_mfma_f32_16x16x32_bf16 v[28:31], v[60:63], v[8:11], v[28:31]
  v_mfma_f32_16x16x32_bf16 v[32:35], v[64:67], v[8:11], v[32:35]
  v_mfma_f32_16x16x32_bf16 v[36:39], v[68:71], v[8:11], v[36:39]
  ds_read_b64_tr_b16 v[56:57], v52 offset:4096
  ds_read_b64_tr_b16 v[58:59], v52 offset:4608
  ds_read_b64_tr_b16 v[60:61], v52 offset:4128
  ds_read_b64_tr_b16 v[62:63], v52 offset:4640
  ds_read_b64_tr_b16 v[64:65], v52 offset:4160
  ds_read_b64_tr_b16 v[66:67], v52 offset:4672
  ds_read_b64_tr_b16 v[68:69], v52 offset:4192
  ds_read_b64_tr_b16 v[70:71], v52 offset:4704
  s_waitcnt lgkmcnt(0)
  v_mfma_f32_16x16x32_bf16 v[24:27], v[56:59], v[12:15], v[24:27]
  v_mfma_f32_16x16x32_bf16 v[28:31], v[60:63], v[12:15], v[28:31]
  v_mfma_f32_16x16x32_bf16 v[32:35], v[64:67], v[12:15], v[32:35]
  v_mfma_f32_16x16x32_bf16 v[36:39], v[68:71], v[12:15], v[36:39]
  ds_read_b64_tr_b16 v[56:57], v53 offset:8192
  ds_read_b64_tr_b16 v[58:59], v53 offset:8704
  ds_read_b64_tr_b16 v[60:61], v53 offset:8224
  ds_read_b64_tr_b16 v[62:63], v53 offset:8736
  ds_read_b64_tr_b16 v[64:65], v53 offset:8256
  ds_read_b64_tr_b16 v[66:67], v53 offset:8768
  ds_read_b64_tr_b16 v[68:69], v53 offset:8288
  ds_read_b64_tr_b16 v[70:71], v53 offset:8800
  s_waitcnt lgkmcnt(0)
  v_mfma_f32_16x16x32_bf16 v[24:27], v[56:59], v[16:19], v[24:27]
  v_mfma_f32_16x16x32_bf16 v[28:31], v[60:63], v[16:19], v[28:31]
  v_mfma_f32_16x16x32_bf16 v[32:35], v[64:67], v[16:19], v[32:35]
  v_mfma_f32_16x16x32_bf16 v[36:39], v[68:71], v[16:19], v[36:39]
  v_and_b32 v6, 1, v4
  v_mul_u32_u24 v6, 12288, v6
  v_lshrrev_b32 v7, 1, v4
  v_lshl_add_u32 v7, v5, 1, v7
  v_lshlrev_b32 v7, 4, v7
  v_add_u32 v6, v6, v7
  s_mul_i32 s56, s35, 24576
  s_lshl_b32 s57, s38, 12
  s_add_u32 s56, s56, s57
  s_lshl_b32 s57, s31, 9
  s_add_u32 s56, s56, s57
  s_add_u32 s56, s56, 65536
  v_and_b32 v7, 2, v4
  v_cmp_eq_u32 vcc, 2, v7
  s_waitcnt lgkmcnt(0)
  s_add_u32 s36, s36, 1
  v_mov_b32 v10, s36
  v_mov_b32 v11, s37
  s_nop 7
  s_mov_b64 s[84:85], exec
  s_mov_b32 exec_lo, 0x000f000f
  s_mov_b32 exec_hi, 0x000f000f
  v_cndmask_b32 v8, v24, v26, vcc
  v_cndmask_b32 v9, v25, v27, vcc
  buffer_store_dwordx4 v[8:11], v6, s[52:55], s56 offen offset:0 sc1
  s_nop 1
  v_cndmask_b32 v8, v28, v30, vcc
  v_cndmask_b32 v9, v29, v31, vcc
  buffer_store_dwordx4 v[8:11], v6, s[52:55], s56 offen offset:128 sc1
  s_nop 1
  v_cndmask_b32 v8, v32, v34, vcc
  v_cndmask_b32 v9, v33, v35, vcc
  buffer_store_dwordx4 v[8:11], v6, s[52:55], s56 offen offset:256 sc1
  s_nop 1
  v_cndmask_b32 v8, v36, v38, vcc
  v_cndmask_b32 v9, v37, v39, vcc
  buffer_store_dwordx4 v[8:11], v6, s[52:55], s56 offen offset:384 sc1
  s_nop 1
  s_mul_i32 s56, s35, 768
  s_lshl_b32 s57, s38, 7
  s_add_u32 s56, s56, s57
  s_lshl_b32 s57, s31, 3
  s_add_u32 s56, s56, s57
  s_add_u32 s56, s56, 884736
  s_mov_b64 exec, 3
  v_mul_u32_u24 v7, 384, v0
  s_getreg_b32 s39, hwreg(HW_REG_XCC_ID, 0, 4)
  s_add_u32 s39, s39, 1
  s_lshl_b32 s39, s39, 24
  s_add_u32 s39, s39, s37
  v_mov_b32 v9, s39
  v_mov_b32 v8, s36
  buffer_store_dwordx2 v[8:9], v7, s[52:55], s56 offen sc1
  s_mov_b64 exec, s[84:85]
  s_mul_i32 s56, s35, 24576
  s_mul_i32 s57, s32, 12288
  s_add_u32 s56, s56, s57
  s_lshl_b32 s57, s38, 12
  s_add_u32 s56, s56, s57
  s_add_u32 s56, s56, 65536
  s_mov_b32 s80, 1048576
  s_mul_i32 s57, s35, 768
  s_mul_i32 s58, s32, 384
  s_add_u32 s57, s57, s58
  s_lshl_b32 s58, s38, 7
  s_add_u32 s57, s57, s58
  s_add_u32 s57, s57, 884736
  s_add_u32 s58, s26, s57
  s_addc_u32 s59, s27, 0
L_sp_1:
  s_load_dwordx16 s[64:79], s[58:59], 0 glc
  s_waitcnt lgkmcnt(0)
  s_cmp_eq_u32 s64, s36
  s_cbranch_scc0 L_sm_3
  s_cmp_eq_u32 s66, s36
  s_cbranch_scc0 L_sm_3
  s_cmp_eq_u32 s68, s36
  s_cbranch_scc0 L_sm_3
  s_cmp_eq_u32 s70, s36
  s_cbranch_scc0 L_sm_3
  s_cmp_eq_u32 s72, s36
  s_cbranch_scc0 L_sm_3
  s_cmp_eq_u32 s74, s36
  s_cbranch_scc0 L_sm_3
  s_cmp_eq_u32 s76, s36
  s_cbranch_scc0 L_sm_3
  s_cmp_eq_u32 s78, s36
  s_cbranch_scc0 L_sm_3
  s_branch L_sd_2
L_sm_3:
  s_sub_u32 s80, s80, 1
  s_cmp_eq_u32 s80, 0
  s_cbranch_scc1 L_sd_2
  s_sleep 4
  s_branch L_sp_1
L_sd_2:
  s_mov_b32 s57, 1
  s_cmp_eq_u32 s65, s39
  s_cselect_b32 s57, s57, 0
  s_cmp_eq_u32 s67, s39
  s_cselect_b32 s57, s57, 0
  s_cmp_eq_u32 s69, s39
  s_cselect_b32 s57, s57, 0
  s_cmp_eq_u32 s71, s39
  s_cselect_b32 s57, s57, 0
  s_cmp_eq_u32 s73, s39
  s_cselect_b32 s57, s57, 0
  s_cmp_eq_u32 s75, s39
  s_cselect_b32 s57, s57, 0
  s_cmp_eq_u32 s77, s39
  s_cselect_b32 s57, s57, 0
  s_cmp_eq_u32 s79, s39
  s_cselect_b32 s57, s57, 0
  v_mov_b32 v7, s57
  v_mov_b32 v6, 0
  ds_write_b32 v6, v7 offset:4052
  v_lshlrev_b32 v6, 4, v0
L_q_poll:
  buffer_load_dwordx4 v[24:27], v6, s[52:55], s56 offen offset:0 sc1
  buffer_load_dwordx4 v[28:31], v6, s[52:55], s56 offen offset:1024 sc1
  buffer_load_dwordx4 v[32:35], v6, s[52:55], s56 offen offset:2048 sc1
  buffer_load_dwordx4 v[36:39], v6, s[52:55], s56 offen offset:3072 sc1
  s_waitcnt vmcnt(0)
  v_cmp_ne_u64 vcc, s[36:37], v[26:27]
  s_mov_b64 s[82:83], vcc
  v_cmp_ne_u64 vcc, s[36:37], v[30:31]
  s_or_b64 s[82:83], s[82:83], vcc
  v_cmp_ne_u64 vcc, s[36:37], v[34:35]
  s_or_b64 s[82:83], s[82:83], vcc
  v_cmp_ne_u64 vcc, s[36:37], v[38:39]
  s_or_b64 s[82:83], s[82:83], vcc
  s_cmp_eq_u64 s[82:83], 0
  s_cbranch_scc1 L_pd_4
  s_sub_u32 s80, s80, 1
  s_cmp_eq_u32 s80, 0
  s_cbranch_scc1 L_pd_4
  s_sleep 1
  s_branch L_q_poll
L_pd_4:
  v_add_f32 v24, v24, v28
  v_add_f32 v25, v25, v29
  v_add_f32 v32, v32, v36
  v_add_f32 v33, v33, v37
  v_add_f32 v24, v24, v32
  v_add_f32 v25, v25, v33
  v_mov_b32 v26, v24
  s_nop 1
  v_permlane32_swap_b32 v24, v26
  v_add_f32 v24, v24, v26
  v_mov_b32 v26, v25
  s_nop 1
  v_permlane32_swap_b32 v25, v26
  v_add_f32 v25, v25, v26
  v_cvt_pk_bf16_f32 v24, v24, v25
  v_and_b32 v6, 31, v0
  v_lshlrev_b32 v6, 2, v6
  s_lshl_b32 s57, s38, 7
  v_add_u32 v6, s57, v6
  ds_write_b32 v6, v24 offset:2560
  v_mov_b32 v7, 0
  ds_write_b32 v7, v7 offset:4048
  ds_write_b32 v7, v7 offset:4032
  ds_write_b32 v7, v7 offset:4036
  ds_write_b32 v7, v7 offset:4040
  ds_write_b32 v7, v7 offset:4044
  s_waitcnt lgkmcnt(0)
  s_barrier
  v_add_u32 v5, 0, v0
  v_mul_u32_u24 v6, 6554, v5
  v_lshrrev_b32 v6, 16, v6
  v_mul_u32_u24 v7, 10, v6
  v_sub_u32 v5, v5, v7
  v_mul_u32_u24 v6, 1280, v6
  v_lshlrev_b32 v5, 4, v5
  v_add_u32 v40, v5, v6
  v_add_u32 v5, 64, v0
  v_mul_u32_u24 v6, 6554, v5
  v_lshrrev_b32 v6, 16, v6
  v_mul_u32_u24 v7, 10, v6
  v_sub_u32 v5, v5, v7
  v_mul_u32_u24 v6, 1280, v6
  v_lshlrev_b32 v5, 4, v5
  v_add_u32 v41, v5, v6
  v_add_u32 v5, 128, v0
  v_mul_u32_u24 v6, 6554, v5
  v_lshrrev_b32 v6, 16, v6
  v_mul_u32_u24 v7, 10, v6
  v_sub_u32 v5, v5, v7
  v_mul_u32_u24 v6, 1280, v6
  v_lshlrev_b32 v5, 4, v5
  v_add_u32 v42, v5, v6
  v_add_u32 v5, 192, v0
  v_mul_u32_u24 v6, 6554, v5
  v_lshrrev_b32 v6, 16, v6
  v_mul_u32_u24 v7, 10, v6
  v_sub_u32 v5, v5, v7
  v_mul_u32_u24 v6, 1280, v6
  v_lshlrev_b32 v5, 4, v5
  v_add_u32 v43, v5, v6
  v_add_u32 v5, 256, v0
  v_mul_u32_u24 v6, 6554, v5
  v_lshrrev_b32 v6, 16, v6
  v_mul_u32_u24 v7, 10, v6
  v_sub_u32 v5, v5, v7
  v_mul_u32_u24 v6, 1280, v6
  v_lshlrev_b32 v5, 4, v5
  v_add_u32 v44, v5, v6
  s_mov_b32 s48, s12
  s_and_b32 s49, s13, 0xffff
  s_mov_b32 s50, 7864320
  s_mov_b32 s51, 0x20000
  s_mov_b32 s88, s20
  s_and_b32 s89, s21, 0xffff
  s_mov_b32 s90, 1966080
  s_mov_b32 s91, 0x20000
  s_mul_i32 s56, s35, 61440
  s_mul_i32 s57, s31, 160
  s_add_u32 s56, s56, s57
  s_cmp_eq_u32 s38, 0
  s_cbranch_scc1 L_wd_5
  s_cmp_eq_u32 s38, 1
  s_cbranch_scc1 L_wd_6
  s_mov_b32 m0, 93184
  s_add_u32 s57, s56, 40960
  buffer_load_dwordx4 v41, s[88:91], s57 offen  lds
  s_mov_b32 m0, 94208
  s_add_u32 s57, s56, 40960
  buffer_load_dwordx4 v42, s[88:91], s57 offen  lds
  s_branch L_wd_7
L_wd_5:
  s_mov_b32 m0, 87040
  s_add_u32 s57, s56, 0
  buffer_load_dwordx4 v40, s[88:91], s57 offen  lds
  s_mov_b32 m0, 88064
  s_add_u32 s57, s56, 0
  buffer_load_dwordx4 v41, s[88:91], s57 offen  lds
  s_mov_b32 m0, 89088
  s_add_u32 s57, s56, 0
  buffer_load_dwordx4 v42, s[88:91], s57 offen  lds
  s_branch L_wd_7
L_wd_6:
  s_mov_b32 m0, 90112
  s_add_u32 s57, s56, 0
  buffer_load_dwordx4 v43, s[88:91], s57 offen  lds
  s_mov_b32 m0, 91136
  s_add_u32 s57, s56, 0
  buffer_load_dwordx4 v44, s[88:91], s57 offen  lds
  s_mov_b32 m0, 92160
  s_add_u32 s57, s56, 40960
  buffer_load_dwordx4 v40, s[88:91], s57 offen  lds
L_wd_7:
  v_mov_b32 v238, s36
  v_mov_b32 v239, s37
  v_mov_b32 v240, 0
  v_mov_b32 v241, 1
  s_lshl_b32 s64, s28, 6
  v_add_u32 v225, s64, v0
  v_mov_b32 v224, 96
  v_cmp_eq_u32 vcc, v224, v225
  s_mov_b64 s[74:75], vcc
  v_cmp_ge_u32 vcc, v224, v225
  s_mov_b64 s[72:73], vcc
  v_min_u32 v224, 95, v225
  v_lshlrev_b32 v224, 3, v224
  v_lshlrev_b32 v225, 4, v225
  s_lshl_b32 s64, s35, 3
  s_add_u32 s64, s64, s31
  s_lshl_b32 s64, s64, 11
  s_add_u32 s64, s64, 1310720
  s_sub_u32 s65, s28, 2
  s_cmp_ge_i32 s65, 3
  s_cselect_b32 s66, 1, 0
  s_mul_i32 s67, s66, 3
  s_sub_u32 s67, s65, s67
  v_lshrrev_b32 v227, 5, v0
  v_lshlrev_b32 v227, 11, v227
  v_and_b32 v228, 31, v0
  s_lshl_b32 s68, s67, 5
  v_add_u32 v226, s68, v228
  v_lshl_add_u32 v226, v226, 4, v227
  v_add_u32 v227, 1536, v227
  s_mul_i32 s68, s66, 384
  s_lshl_b32 s69, s67, 7
  s_add_u32 s68, s68, s69
  s_add_u32 s68, s68, 3200
  v_lshl_add_u32 v228, v228, 2, s68
  s_lshl_b32 s65, s35, 3
  s_lshl_b32 s66, s66, 2
  s_add_u32 s65, s65, s66
  s_lshl_b32 s65, s65, 11
  s_add_u32 s65, s65, 1310720
  s_add_u32 s66, s65, 4096
  v_and_b32 v234, 15, v0
  v_lshrrev_b32 v235, 4, v0
  v_and_b32 v236, 1, v0
  v_lshlrev_b32 v237, 4, v235
  v_mul_u32_u24 v229, 384, v236
  v_add_u32 v229, v229, v237
  v_add_u32 v229, 3200, v229
  v_lshlrev_b32 v230, 7, v236
  v_add_u32 v230, v230, v237
  v_add_u32 v230, 2944, v230
  v_lshlrev_b32 v231, 3, v235
  v_lshrrev_b32 v232, 2, v234
  v_add_u32 v231, v231, v232
  v_mul_u32_u24 v231, 160, v231
  v_and_b32 v232, 3, v234
  v_lshlrev_b32 v232, 3, v232
  s_lshl_b32 s67, s28, 5
  v_add3_u32 v231, v231, v232, s67
  v_add_u32 v231, 56320, v231
  v_cmp_le_u32 vcc, 2, v235
  v_subrev_u32 v232, 2560, v231
  s_nop 0
  v_cndmask_b32 v232, v231, v232, vcc
  v_and_b32 v233, 1, v235
  v_mul_u32_u24 v233, 40960, v233
  v_lshrrev_b32 v237, 3, v234
  v_lshl_add_u32 v233, v237, 12, v233
  v_and_b32 v237, 7, v234
  v_lshl_add_u32 v233, v237, 4, v233
  v_and_b32 v237, 16, v0
  v_cmp_eq_u32 vcc, 16, v237
  s_mov_b64 s[76:77], vcc
  s_mul_i32 s67, s31, 10
  s_add_u32 s67, s67, s28
  s_lshl_b32 s67, s67, 13
  s_lshl_b32 s68, s35, 7
  s_add_u32 s67, s67, s68
  s_add_u32 s67, s67, 1835008
  s_lshl_b32 s71, s30, 3
  s_add_u32 s71, s71, s29
  s_lshr_b32 s69, s29, 1
  s_add_u32 s69, s69, 16
  s_bitcmp1_b32 s29, 0
  s_cselect_b32 s69, 99, s69
  s_cmp_eq_u32 s30, 2
  s_cselect_b32 s71, s69, s71
  s_cmp_eq_u32 s30, 3
  s_cselect_b32 s71, 99, s71
  s_cmp_ge_u32 s71, 10
  s_cselect_b32 s69, 1, 0
  s_mul_i32 s70, s69, 10
  s_sub_u32 s70, s71, s70
  s_lshl_b32 s68, s31, 1
  s_add_u32 s68, s68, s69
  s_mul_i32 s68, s68, 10
  s_add_u32 s68, s68, s70
  s_lshl_b32 s68, s68, 12
  s_add_u32 s68, s68, 1835008
  s_mul_i32 s69, s69, 1280
  s_mul_i32 s81, s31, 160
  s_add_u32 s69, s69, s81
  s_lshl_b32 s70, s70, 4
  s_add_u32 s70, s69, s70
  v_and_b32 v234, 7, v0
  s_add_u32 s69, s68, 4096
  s_mov_b32 s40, s4
  s_and_b32 s41, s5, 0xffff
  s_mov_b32 s42, 2560
  s_mov_b32 s43, 0x20000
  s_mov_b32 s44, s22
  s_and_b32 s45, s23, 0xffff
  s_mov_b32 s46, 2560
  s_mov_b32 s47, 0x20000
  v_lshlrev_b32 v235, 1, v234
  v_lshlrev_b32 v234, 4, v0
  buffer_load_ushort v236, v235, s[40:43], s70 offen
  s_waitcnt vmcnt(0)
  v_lshlrev_b32 v236, 16, v236
  s_mov_b32 s80, 1048576
  s_mov_b32 s62, 1069066811
  s_branch L_wlate
  s_waitcnt vmcnt(0)
  s_branch L_tail
L_aux_ffn:
  s_and_b32 s56, s34, 15
  s_mul_i32 s56, s56, 80
  v_add_u32 v6, s56, v6
  ds_read_b128 v[8:11], v6 offset:0
  ds_read_b128 v[12:15], v6 offset:64
  v_mul_u32_u24 v52, 384, v50
  v_add_u32 v52, 40960, v52
  v_add_u32 v52, v52, v51
  v_lshrrev_b32 v53, 2, v4
  v_mul_u32_u24 v53, 384, v53
  v_add_u32 v53, 40960, v53
  v_add_u32 v53, v53, v51
  v_cmp_le_u32 vcc, 1, v5
  v_mov_b32 v64, 0
  v_mov_b32 v65, 0
  v_mov_b32 v66, 0
  v_mov_b32 v67, 0
  v_mov_b32 v68, 0
  v_mov_b32 v69, 0
  v_mov_b32 v70, 0
  v_mov_b32 v71, 0
  v_mov_b32 v72, 0
  v_mov_b32 v73, 0
  v_mov_b32 v74, 0
  v_mov_b32 v75, 0
  v_mov_b32 v76, 0
  v_mov_b32 v77, 0
  v_mov_b32 v78, 0
  v_mov_b32 v79, 0
  v_mov_b32 v80, 0
  v_mov_b32 v81, 0
  v_mov_b32 v82, 0
  v_mov_b32 v83, 0
  v_mov_b32 v84, 0
  v_mov_b32 v85, 0
  v_mov_b32 v86, 0
  v_mov_b32 v87, 0
  v_mov_b32 v88, 0
  v_mov_b32 v89, 0
  v_mov_b32 v90, 0
  v_mov_b32 v91, 0
  v_mov_b32 v92, 0
  v_mov_b32 v93, 0
  v_mov_b32 v94, 0
  v_mov_b32 v95, 0
  v_mov_b32 v96, 0
  v_mov_b32 v97, 0
  v_mov_b32 v98, 0
  v_mov_b32 v99, 0
  v_mov_b32 v100, 0
  v_mov_b32 v101, 0
  v_mov_b32 v102, 0
  v_mov_b32 v103, 0
  v_mov_b32 v104, 0
  v_mov_b32 v105, 0
  v_mov_b32 v106, 0
  v_mov_b32 v107, 0
  v_mov_b32 v108, 0
  v_mov_b32 v109, 0
  v_mov_b32 v110, 0
  v_mov_b32 v111, 0
  s_waitcnt lgkmcnt(0)
  v_cndmask_b32 v12, v12, 0, vcc
  v_cndmask_b32 v13, v13, 0, vcc
  v_cndmask_b32 v14, v14, 0, vcc
  v_cndmask_b32 v15, v15, 0, vcc
  s_barrier
  v_add_u32 v43, 0, v0
  v_mul_u32_u24 v44, 2731, v43
  v_lshrrev_b32 v44, 16, v44
  v_mul_u32_u24 v45, 24, v44
  v_sub_u32 v43, v43, v45
  v_mul_u32_u24 v44, 3072, v44
  v_lshlrev_b32 v43, 4, v43
  v_add_u32 v40, v43, v44
  v_add_u32 v43, 64, v0
  v_mul_u32_u24 v44, 2731, v43
  v_lshrrev_b32 v44, 16, v44
  v_mul_u32_u24 v45, 24, v44
  v_sub_u32 v43, v43, v45
  v_mul_u32_u24 v44, 3072, v44
  v_lshlrev_b32 v43, 4, v43
  v_add_u32 v41, v43, v44
  v_add_u32 v43, 128, v0
  v_mul_u32_u24 v44, 2731, v43
  v_lshrrev_b32 v44, 16, v44
  v_mul_u32_u24 v45, 24, v44
  v_sub_u32 v43, v43, v45
  v_mul_u32_u24 v44, 3072, v44
  v_lshlrev_b32 v43, 4, v43
  v_add_u32 v42, v43, v44
  s_and_b32 s56, s34, 15
  s_mul_i32 s56, s56, 122880
  s_mul_i32 s57, s29, 384
  s_add_u32 s56, s56, s57
  s_mov_b32 s57, 40960
  s_mov_b32 m0, s57
  s_add_u32 s57, s57, 1024
  buffer_load_dwordx4 v40, s[44:47], s56 offen nt lds
  s_mov_b32 m0, s57
  s_add_u32 s57, s57, 1024
  buffer_load_dwordx4 v41, s[44:47], s56 offen nt lds
  s_mov_b32 m0, s57
  s_add_u32 s57, s57, 1024
  buffer_load_dwordx4 v42, s[44:47], s56 offen nt lds
  s_add_u32 s56, s56, 24576
  s_mov_b32 m0, s57
  s_add_u32 s57, s57, 1024
  buffer_load_dwordx4 v40, s[44:47], s56 offen nt lds
  s_mov_b32 m0, s57
  s_add_u32 s57, s57, 1024
  buffer_load_dwordx4 v41, s[44:47], s56 offen nt lds
  s_mov_b32 m0, s57
  s_add_u32 s57, s57, 1024
  buffer_load_dwordx4 v42, s[44:47], s56 offen nt lds
  s_add_u32 s56, s56, 24576
  s_mov_b32 m0, s57
  s_add_u32 s57, s57, 1024
  buffer_load_dwordx4 v40, s[44:47], s56 offen nt lds
  s_mov_b32 m0, s57
  s_add_u32 s57, s57, 1024
  buffer_load_dwordx4 v41, s[44:47], s56 offen nt lds
  s_mov_b32 m0, s57
  s_add_u32 s57, s57, 1024
  buffer_load_dwordx4 v42, s[44:47], s56 offen nt lds
  s_add_u32 s56, s56, 24576
  s_mov_b32 m0, s57
  s_add_u32 s57, s57, 1024
  buffer_load_dwordx4 v40, s[44:47], s56 offen nt lds
  s_mov_b32 m0, s57
  s_add_u32 s57, s57, 1024
  buffer_load_dwordx4 v41, s[44:47], s56 offen nt lds
  s_mov_b32 m0, s57
  s_add_u32 s57, s57, 1024
  buffer_load_dwordx4 v42, s[44:47], s56 offen nt lds
  s_add_u32 s56, s56, 24576
  s_mov_b32 m0, s57
  s_add_u32 s57, s57, 1024
  buffer_load_dwordx4 v40, s[44:47], s56 offen nt lds
  s_mov_b32 m0, s57
  s_add_u32 s57, s57, 1024
  buffer_load_dwordx4 v41, s[44:47], s56 offen nt lds
  s_mov_b32 m0, s57
  s_add_u32 s57, s57, 1024
  buffer_load_dwordx4 v42, s[44:47], s56 offen nt lds
  s_add_u32 s56, s56, 24576
  s_waitcnt vmcnt(0)
  ds_read_b64_tr_b16 v[24:25], v52 offset:0
  ds_read_b64_tr_b16 v[26:27], v52 offset:1536
  ds_read_b64_tr_b16 v[28:29], v52 offset:32
  ds_read_b64_tr_b16 v[30:31], v52 offset:1568
  ds_read_b64_tr_b16 v[32:33], v52 offset:64
  ds_read_b64_tr_b16 v[34:35], v52 offset:1600
  ds_read_b64_tr_b16 v[36:37], v52 offset:96
  ds_read_b64_tr_b16 v[38:39], v52 offset:1632
  s_waitcnt lgkmcnt(0)
  v_mfma_f32_16x16x32_bf16 v[64:67], v[24:27], v[8:11], v[64:67]
  v_mfma_f32_16x16x32_bf16 v[68:71], v[28:31], v[8:11], v[68:71]
  v_mfma_f32_16x16x32_bf16 v[72:75], v[32:35], v[8:11], v[72:75]
  v_mfma_f32_16x16x32_bf16 v[76:79], v[36:39], v[8:11], v[76:79]
  ds_read_b64_tr_b16 v[24:25], v52 offset:128
  ds_read_b64_tr_b16 v[26:27], v52 offset:1664
  ds_read_b64_tr_b16 v[28:29], v52 offset:160
  ds_read_b64_tr_b16 v[30:31], v52 offset:1696
  ds_read_b64_tr_b16 v[32:33], v52 offset:192
  ds_read_b64_tr_b16 v[34:35], v52 offset:1728
  ds_read_b64_tr_b16 v[36:37], v52 offset:224
  ds_read_b64_tr_b16 v[38:39], v52 offset:1760
  s_waitcnt lgkmcnt(0)
  v_mfma_f32_16x16x32_bf16 v[80:83], v[24:27], v[8:11], v[80:83]
  v_mfma_f32_16x16x32_bf16 v[84:87], v[28:31], v[8:11], v[84:87]
  v_mfma_f32_16x16x32_bf16 v[88:91], v[32:35], v[8:11], v[88:91]
  v_mfma_f32_16x16x32_bf16 v[92:95], v[36:39], v[8:11], v[92:95]
  ds_read_b64_tr_b16 v[24:25], v52 offset:256
  ds_read_b64_tr_b16 v[26:27], v52 offset:1792
  ds_read_b64_tr_b16 v[28:29], v52 offset:288
  ds_read_b64_tr_b16 v[30:31], v52 offset:1824
  ds_read_b64_tr_b16 v[32:33], v52 offset:320
  ds_read_b64_tr_b16 v[34:35], v52 offset:1856
  ds_read_b64_tr_b16 v[36:37], v52 offset:352
  ds_read_b64_tr_b16 v[38:39], v52 offset:1888
  s_waitcnt lgkmcnt(0)
  v_mfma_f32_16x16x32_bf16 v[96:99], v[24:27], v[8:11], v[96:99]
  v_mfma_f32_16x16x32_bf16 v[100:103], v[28:31], v[8:11], v[100:103]
  v_mfma_f32_16x16x32_bf16 v[104:107], v[32:35], v[8:11], v[104:107]
  v_mfma_f32_16x16x32_bf16 v[108:111], v[36:39], v[8:11], v[108:111]
  ds_read_b64_tr_b16 v[24:25], v53 offset:12288
  ds_read_b64_tr_b16 v[26:27], v53 offset:13824
  ds_read_b64_tr_b16 v[28:29], v53 offset:12320
  ds_read_b64_tr_b16 v[30:31], v53 offset:13856
  ds_read_b64_tr_b16 v[32:33], v53 offset:12352
  ds_read_b64_tr_b16 v[34:35], v53 offset:13888
  ds_read_b64_tr_b16 v[36:37], v53 offset:12384
  ds_read_b64_tr_b16 v[38:39], v53 offset:13920
  s_waitcnt lgkmcnt(0)
  v_mfma_f32_16x16x32_bf16 v[64:67], v[24:27], v[12:15], v[64:67]
  v_mfma_f32_16x16x32_bf16 v[68:71], v[28:31], v[12:15], v[68:71]
  v_mfma_f32_16x16x32_bf16 v[72:75], v[32:35], v[12:15], v[72:75]
  v_mfma_f32_16x16x32_bf16 v[76:79], v[36:39], v[12:15], v[76:79]
  ds_read_b64_tr_b16 v[24:25], v53 offset:12416
  ds_read_b64_tr_b16 v[26:27], v53 offset:13952
  ds_read_b64_tr_b16 v[28:29], v53 offset:12448
  ds_read_b64_tr_b16 v[30:31], v53 offset:13984
  ds_read_b64_tr_b16 v[32:33], v53 offset:12480
  ds_read_b64_tr_b16 v[34:35], v53 offset:14016
  ds_read_b64_tr_b16 v[36:37], v53 offset:12512
  ds_read_b64_tr_b16 v[38:39], v53 offset:14048
  s_waitcnt lgkmcnt(0)
  v_mfma_f32_16x16x32_bf16 v[80:83], v[24:27], v[12:15], v[80:83]
  v_mfma_f32_16x16x32_bf16 v[84:87], v[28:31], v[12:15], v[84:87]
  v_mfma_f32_16x16x32_bf16 v[88:91], v[32:35], v[12:15], v[88:91]
  v_mfma_f32_16x16x32_bf16 v[92:95], v[36:39], v[12:15], v[92:95]
  ds_read_b64_tr_b16 v[24:25], v53 offset:12544
  ds_read_b64_tr_b16 v[26:27], v53 offset:14080
  ds_read_b64_tr_b16 v[28:29], v53 offset:12576
  ds_read_b64_tr_b16 v[30:31], v53 offset:14112
  ds_read_b64_tr_b16 v[32:33], v53 offset:12608
  ds_read_b64_tr_b16 v[34:35], v53 offset:14144
  ds_read_b64_tr_b16 v[36:37], v53 offset:12640
  ds_read_b64_tr_b16 v[38:39], v53 offset:14176
  s_waitcnt lgkmcnt(0)
  v_mfma_f32_16x16x32_bf16 v[96:99], v[24:27], v[12:15], v[96:99]
  v_mfma_f32_16x16x32_bf16 v[100:103], v[28:31], v[12:15], v[100:103]
  v_mfma_f32_16x16x32_bf16 v[104:107], v[32:35], v[12:15], v[104:107]
  v_mfma_f32_16x16x32_bf16 v[108:111], v[36:39], v[12:15], v[108:111]
  v_and_b32 v6, 1, v4
  v_mul_u32_u24 v6, 192, v6
  v_lshlrev_b32 v7, 4, v5
  v_add_u32 v6, v6, v7
  s_mul_i32 s56, s29, 49152
  s_mul_i32 s57, s34, 384
  s_add_u32 s56, s56, s57
  s_add_u32 s56, s56, 917504
  s_add_u32 s36, s36, 1
  s_nop 7
  s_mov_b32 exec_lo, 0x00030003
  s_mov_b32 exec_hi, 0x00030003
  buffer_store_dwordx4 v[64:67], v6, s[52:55], s56 offen offset:0 sc1
  buffer_store_dwordx4 v[68:71], v6, s[52:55], s56 offen offset:64 sc1
  buffer_store_dwordx4 v[72:75], v6, s[52:55], s56 offen offset:128 sc1
  s_add_u32 s56, s56, 12288
  buffer_store_dwordx4 v[76:79], v6, s[52:55], s56 offen offset:0 sc1
  buffer_store_dwordx4 v[80:83], v6, s[52:55], s56 offen offset:64 sc1
  buffer_store_dwordx4 v[84:87], v6, s[52:55], s56 offen offset:128 sc1
  s_add_u32 s56, s56, 12288
  buffer_store_dwordx4 v[88:91], v6, s[52:55], s56 offen offset:0 sc1
  buffer_store_dwordx4 v[92:95], v6, s[52:55], s56 offen offset:64 sc1
  buffer_store_dwordx4 v[96:99], v6, s[52:55], s56 offen offset:128 sc1
  s_add_u32 s56, s56, 12288
  buffer_store_dwordx4 v[100:103], v6, s[52:55], s56 offen offset:0 sc1
  buffer_store_dwordx4 v[104:107], v6, s[52:55], s56 offen offset:64 sc1
  buffer_store_dwordx4 v[108:111], v6, s[52:55], s56 offen offset:128 sc1
  s_mov_b64 exec, -1
  s_waitcnt vmcnt(0)
  v_mov_b32 v8, s36
  v_mov_b32 v9, s37
  s_lshl_b32 s56, s29, 8
  s_lshl_b32 s57, s34, 3
  s_add_u32 s57, s57, s56
  s_add_u32 s57, s57, 851968
  s_add_u32 s56, s56, 851968
  v_mov_b32 v10, 0
  s_mov_b64 exec, 1
  buffer_store_dwordx2 v[8:9], v10, s[52:55], s57 offen sc1
  s_mov_b64 exec, -1
  s_mov_b32 s80, 1048576
  v_mov_b32 v12, 0
L_fw_8:
  ds_read_b32 v13, v12 offset:4048
  s_waitcnt lgkmcnt(0)
  v_readfirstlane_b32 s57, v13
  s_cmp_ge_u32 s57, 1
  s_cbranch_scc1 L_fg_9
  s_sleep 8
  s_branch L_fw_8
L_fg_9:
  s_add_u32 s58, s26, s56
  s_addc_u32 s59, s27, 0
L_sp_10:
  s_load_dwordx16 s[64:79], s[58:59], 0 glc
  s_waitcnt lgkmcnt(0)
  s_cmp_eq_u64 s[64:65], s[36:37]
  s_cbranch_scc0 L_sm_12
  s_cmp_eq_u64 s[66:67], s[36:37]
  s_cbranch_scc0 L_sm_12
  s_cmp_eq_u64 s[68:69], s[36:37]
  s_cbranch_scc0 L_sm_12
  s_cmp_eq_u64 s[70:71], s[36:37]
  s_cbranch_scc0 L_sm_12
  s_cmp_eq_u64 s[72:73], s[36:37]
  s_cbranch_scc0 L_sm_12
  s_cmp_eq_u64 s[74:75], s[36:37]
  s_cbranch_scc0 L_sm_12
  s_cmp_eq_u64 s[76:77], s[36:37]
  s_cbranch_scc0 L_sm_12
  s_cmp_eq_u64 s[78:79], s[36:37]
  s_cbranch_scc0 L_sm_12
  s_branch L_sd_11
L_sm_12:
  s_sub_u32 s80, s80, 1
  s_cmp_eq_u32 s80, 0
  s_cbranch_scc1 L_sd_11
  s_sleep 16
  s_branch L_sp_10
L_sd_11:
  s_add_u32 s58, s58, 64
  s_addc_u32 s59, s59, 0
L_sp_13:
  s_load_dwordx16 s[64:79], s[58:59], 0 glc
  s_waitcnt lgkmcnt(0)
  s_cmp_eq_u64 s[64:65], s[36:37]
  s_cbranch_scc0 L_sm_15
  s_cmp_eq_u64 s[66:67], s[36:37]
  s_cbranch_scc0 L_sm_15
  s_cmp_eq_u64 s[68:69], s[36:37]
  s_cbranch_scc0 L_sm_15
  s_cmp_eq_u64 s[70:71], s[36:37]
  s_cbranch_scc0 L_sm_15
  s_cmp_eq_u64 s[72:73], s[36:37]
  s_cbranch_scc0 L_sm_15
  s_cmp_eq_u64 s[74:75], s[36:37]
  s_cbranch_scc0 L_sm_15
  s_cmp_eq_u64 s[76:77], s[36:37]
  s_cbranch_scc0 L_sm_15
  s_cmp_eq_u64 s[78:79], s[36:37]
  s_cbranch_scc0 L_sm_15
  s_branch L_sd_14
L_sm_15:
  s_sub_u32 s80, s80, 1
  s_cmp_eq_u32 s80, 0
  s_cbranch_scc1 L_sd_14
  s_sleep 16
  s_branch L_sp_13
L_sd_14:
  s_add_u32 s58, s58, 64
  s_addc_u32 s59, s59, 0
L_sp_16:
  s_load_dwordx16 s[64:79], s[58:59], 0 glc
  s_waitcnt lgkmcnt(0)
  s_cmp_eq_u64 s[64:65], s[36:37]
  s_cbranch_scc0 L_sm_18
  s_cmp_eq_u64 s[66:67], s[36:37]
  s_cbranch_scc0 L_sm_18
  s_cmp_eq_u64 s[68:69], s[36:37]
  s_cbranch_scc0 L_sm_18
  s_cmp_eq_u64 s[70:71], s[36:37]
  s_cbranch_scc0 L_sm_18
  s_cmp_eq_u64 s[72:73], s[36:37]
  s_cbranch_scc0 L_sm_18
  s_cmp_eq_u64 s[74:75], s[36:37]
  s_cbranch_scc0 L_sm_18
  s_cmp_eq_u64 s[76:77], s[36:37]
  s_cbranch_scc0 L_sm_18
  s_cmp_eq_u64 s[78:79], s[36:37]
  s_cbranch_scc0 L_sm_18
  s_branch L_sd_17
L_sm_18:
  s_sub_u32 s80, s80, 1
  s_cmp_eq_u32 s80, 0
  s_cbranch_scc1 L_sd_17
  s_sleep 16
  s_branch L_sp_16
L_sd_17:
  s_add_u32 s58, s58, 64
  s_addc_u32 s59, s59, 0
L_sp_19:
  s_load_dwordx16 s[64:79], s[58:59], 0 glc
  s_waitcnt lgkmcnt(0)
  s_cmp_eq_u64 s[64:65], s[36:37]
  s_cbranch_scc0 L_sm_21
  s_cmp_eq_u64 s[66:67], s[36:37]
  s_cbranch_scc0 L_sm_21
  s_cmp_eq_u64 s[68:69], s[36:37]
  s_cbranch_scc0 L_sm_21
  s_cmp_eq_u64 s[70:71], s[36:37]
  s_cbranch_scc0 L_sm_21
  s_cmp_eq_u64 s[72:73], s[36:37]
  s_cbranch_scc0 L_sm_21
  s_cmp_eq_u64 s[74:75], s[36:37]
  s_cbranch_scc0 L_sm_21
  s_cmp_eq_u64 s[76:77], s[36:37]
  s_cbranch_scc0 L_sm_21
  s_cmp_eq_u64 s[78:79], s[36:37]
  s_cbranch_scc0 L_sm_21
  s_branch L_sd_20
L_sm_21:
  s_sub_u32 s80, s80, 1
  s_cmp_eq_u32 s80, 0
  s_cbranch_scc1 L_sd_20
  s_sleep 16
  s_branch L_sp_19
L_sd_20:
  v_and_b32 v10, 31, v0
  v_min_u32 v11, 23, v10
  v_lshlrev_b32 v11, 4, v11
  v_lshrrev_b32 v12, 5, v0
  v_mul_u32_u24 v12, 6144, v12
  v_add_u32 v11, v11, v12
  s_mul_i32 s56, s29, 49152
  s_mul_i32 s57, s30, 12288
  s_add_u32 s56, s56, s57
  s_add_u32 s56, s56, 917504
  buffer_load_dwordx4 v[64:67], v11, s[52:55], s56 offen offset:0 sc1
  buffer_load_dwordx4 v[68:71], v11, s[52:55], s56 offen offset:384 sc1
  buffer_load_dwordx4 v[72:75], v11, s[52:55], s56 offen offset:768 sc1
  buffer_load_dwordx4 v[76:79], v11, s[52:55], s56 offen offset:1152 sc1
  buffer_load_dwordx4 v[80:83], v11, s[52:55], s56 offen offset:1536 sc1
  buffer_load_dwordx4 v[84:87], v11, s[52:55], s56 offen offset:1920 sc1
  buffer_load_dwordx4 v[88:91], v11, s[52:55], s56 offen offset:2304 sc1
  buffer_load_dwordx4 v[92:95], v11, s[52:55], s56 offen offset:2688 sc1
  s_add_u32 s56, s56, 3072
  buffer_load_dwordx4 v[96:99], v11, s[52:55], s56 offen offset:0 sc1
  buffer_load_dwordx4 v[100:103], v11, s[52:55], s56 offen offset:384 sc1
  buffer_load_dwordx4 v[104:107], v11, s[52:55], s56 offen offset:768 sc1
  buffer_load_dwordx4 v[108:111], v11, s[52:55], s56 offen offset:1152 sc1
  buffer_load_dwordx4 v[112:115], v11, s[52:55], s56 offen offset:1536 sc1
  buffer_load_dwordx4 v[116:119], v11, s[52:55], s56 offen offset:1920 sc1
  buffer_load_dwordx4 v[120:123], v11, s[52:55], s56 offen offset:2304 sc1
  buffer_load_dwordx4 v[124:127], v11, s[52:55], s56 offen offset:2688 sc1
  s_waitcnt vmcnt(0)
  v_add_f32 v64, v64, v68
  v_add_f32 v65, v65, v69
  v_add_f32 v66, v66, v70
  v_add_f32 v67, v67, v71
  v_add_f32 v64, v64, v72
  v_add_f32 v65, v65, v73
  v_add_f32 v66, v66, v74
  v_add_f32 v67, v67, v75
  v_add_f32 v64, v64, v76
  v_add_f32 v65, v65, v77
  v_add_f32 v66, v66, v78
  v_add_f32 v67, v67, v79
  v_add_f32 v64, v64, v80
  v_add_f32 v65, v65, v81
  v_add_f32 v66, v66, v82
  v_add_f32 v67, v67, v83
  v_add_f32 v64, v64, v84
  v_add_f32 v65, v65, v85
  v_add_f32 v66, v66, v86
  v_add_f32 v67, v67, v87
  v_add_f32 v64, v64, v88
  v_add_f32 v65, v65, v89
  v_add_f32 v66, v66, v90
  v_add_f32 v67, v67, v91
  v_add_f32 v64, v64, v92
  v_add_f32 v65, v65, v93
  v_add_f32 v66, v66, v94
  v_add_f32 v67, v67, v95
  v_add_f32 v64, v64, v96
  v_add_f32 v65, v65, v97
  v_add_f32 v66, v66, v98
  v_add_f32 v67, v67, v99
  v_add_f32 v64, v64, v100
  v_add_f32 v65, v65, v101
  v_add_f32 v66, v66, v102
  v_add_f32 v67, v67, v103
  v_add_f32 v64, v64, v104
  v_add_f32 v65, v65, v105
  v_add_f32 v66, v66, v106
  v_add_f32 v67, v67, v107
  v_add_f32 v64, v64, v108
  v_add_f32 v65, v65, v109
  v_add_f32 v66, v66, v110
  v_add_f32 v67, v67, v111
  v_add_f32 v64, v64, v112
  v_add_f32 v65, v65, v113
  v_add_f32 v66, v66, v114
  v_add_f32 v67, v67, v115
  v_add_f32 v64, v64, v116
  v_add_f32 v65, v65, v117
  v_add_f32 v66, v66, v118
  v_add_f32 v67, v67, v119
  v_add_f32 v64, v64, v120
  v_add_f32 v65, v65, v121
  v_add_f32 v66, v66, v122
  v_add_f32 v67, v67, v123
  v_add_f32 v64, v64, v124
  v_add_f32 v65, v65, v125
  v_add_f32 v66, v66, v126
  v_add_f32 v67, v67, v127
  v_cvt_pk_bf16_f32 v64, v64, v65
  v_cvt_pk_bf16_f32 v65, v66, v67
  v_mov_b32 v68, v64
  v_mov_b32 v69, v65
  s_nop 1
  v_permlane32_swap_b32 v64, v68
  v_permlane32_swap_b32 v65, v69
  v_lshlrev_b32 v72, 16, v64
  v_and_b32 v73, 0xffff0000, v64
  v_mul_f32 v74, 3216550459, v72
  v_exp_f32 v74, v74
  s_nop 0
  v_add_f32 v74, 1.0, v74
  v_rcp_f32 v74, v74
  s_nop 0
  v_mul_f32 v72, v72, v74
  v_mul_f32 v74, 3216550459, v73
  v_exp_f32 v74, v74
  s_nop 0
  v_add_f32 v74, 1.0, v74
  v_rcp_f32 v74, v74
  s_nop 0
  v_mul_f32 v73, v73, v74
  v_cvt_pk_bf16_f32 v72, v72, v73
  v_and_b32 v73, 0xffff0000, v72
  v_lshlrev_b32 v72, 16, v72
  v_and_b32 v75, 0xffff0000, v68
  v_lshlrev_b32 v74, 16, v68
  v_mul_f32 v72, v72, v74
  v_mul_f32 v73, v73, v75
  v_cvt_pk_bf16_f32 v76, v72, v73
  v_lshlrev_b32 v72, 16, v65
  v_and_b32 v73, 0xffff0000, v65
  v_mul_f32 v74, 3216550459, v72
  v_exp_f32 v74, v74
  s_nop 0
  v_add_f32 v74, 1.0, v74
  v_rcp_f32 v74, v74
  s_nop 0
  v_mul_f32 v72, v72, v74
  v_mul_f32 v74, 3216550459, v73
  v_exp_f32 v74, v74
  s_nop 0
  v_add_f32 v74, 1.0, v74
  v_rcp_f32 v74, v74
  s_nop 0
  v_mul_f32 v73, v73, v74
  v_cvt_pk_bf16_f32 v72, v72, v73
  v_and_b32 v73, 0xffff0000, v72
  v_lshlrev_b32 v72, 16, v72
  v_and_b32 v75, 0xffff0000, v69
  v_lshlrev_b32 v74, 16, v69
  v_mul_f32 v72, v72, v74
  v_mul_f32 v73, v73, v75
  v_cvt_pk_bf16_f32 v77, v72, v73
  v_cmp_le_u32 vcc, 12, v10
  v_subrev_u32 v11, 12, v10
  s_nop 0
  v_cndmask_b32 v11, v10, v11, vcc
  v_lshlrev_b32 v11, 3, v11
  v_add_u32 v12, 128, v11
  v_cndmask_b32 v11, v11, v12, vcc
  v_subrev_u32 v12, 24, v10
  v_lshrrev_b32 v13, 2, v12
  v_lshlrev_b32 v13, 7, v13
  v_and_b32 v12, 3, v12
  v_lshl_add_u32 v12, v12, 3, v13
  v_add_u32 v12, 96, v12
  v_cmp_le_u32 vcc, 24, v10
  s_nop 1
  v_cndmask_b32 v11, v11, v12, vcc
  v_cndmask_b32 v76, v76, 0, vcc
  v_cndmask_b32 v77, v77, 0, vcc
  s_mov_b32 exec_hi, 0
  ds_write_b64 v11, v[76:77] offset:2944
  s_mov_b64 exec, -1
  s_waitcnt lgkmcnt(0)
  v_mov_b32 v238, s36
  v_mov_b32 v239, s37
  v_mov_b32 v240, 0
  v_mov_b32 v241, 1
  s_lshl_b32 s64, s28, 6
  v_add_u32 v225, s64, v0
  v_mov_b32 v224, 96
  v_cmp_eq_u32 vcc, v224, v225
  s_mov_b64 s[74:75], vcc
  v_cmp_ge_u32 vcc, v224, v225
  s_mov_b64 s[72:73], vcc
  v_min_u32 v224, 95, v225
  v_lshlrev_b32 v224, 3, v224
  v_lshlrev_b32 v225, 4, v225
  s_lshl_b32 s64, s35, 3
  s_add_u32 s64, s64, s31
  s_lshl_b32 s64, s64, 11
  s_add_u32 s64, s64, 1310720
  s_sub_u32 s65, s28, 2
  s_cmp_ge_i32 s65, 3
  s_cselect_b32 s66, 1, 0
  s_mul_i32 s67, s66, 3
  s_sub_u32 s67, s65, s67
  v_lshrrev_b32 v227, 5, v0
  v_lshlrev_b32 v227, 11, v227
  v_and_b32 v228, 31, v0
  s_lshl_b32 s68, s67, 5
  v_add_u32 v226, s68, v228
  v_lshl_add_u32 v226, v226, 4, v227
  v_add_u32 v227, 1536, v227
  s_mul_i32 s68, s66, 384
  s_lshl_b32 s69, s67, 7
  s_add_u32 s68, s68, s69
  s_add_u32 s68, s68, 3200
  v_lshl_add_u32 v228, v228, 2, s68
  s_lshl_b32 s65, s35, 3
  s_lshl_b32 s66, s66, 2
  s_add_u32 s65, s65, s66
  s_lshl_b32 s65, s65, 11
  s_add_u32 s65, s65, 1310720
  s_add_u32 s66, s65, 4096
  v_and_b32 v234, 15, v0
  v_lshrrev_b32 v235, 4, v0
  v_and_b32 v236, 1, v0
  v_lshlrev_b32 v237, 4, v235
  v_mul_u32_u24 v229, 384, v236
  v_add_u32 v229, v229, v237
  v_add_u32 v229, 3200, v229
  v_lshlrev_b32 v230, 7, v236
  v_add_u32 v230, v230, v237
  v_add_u32 v230, 2944, v230
  v_lshlrev_b32 v231, 3, v235
  v_lshrrev_b32 v232, 2, v234
  v_add_u32 v231, v231, v232
  v_mul_u32_u24 v231, 160, v231
  v_and_b32 v232, 3, v234
  v_lshlrev_b32 v232, 3, v232
  s_lshl_b32 s67, s28, 5
  v_add3_u32 v231, v231, v232, s67
  v_add_u32 v231, 56320, v231
  v_cmp_le_u32 vcc, 2, v235
  v_subrev_u32 v232, 2560, v231
  s_nop 0
  v_cndmask_b32 v232, v231, v232, vcc
  v_and_b32 v233, 1, v235
  v_mul_u32_u24 v233, 40960, v233
  v_lshrrev_b32 v237, 3, v234
  v_lshl_add_u32 v233, v237, 12, v233
  v_and_b32 v237, 7, v234
  v_lshl_add_u32 v233, v237, 4, v233
  v_and_b32 v237, 16, v0
  v_cmp_eq_u32 vcc, 16, v237
  s_mov_b64 s[76:77], vcc
  s_mul_i32 s67, s31, 10
  s_add_u32 s67, s67, s28
  s_lshl_b32 s67, s67, 13
  s_lshl_b32 s68, s35, 7
  s_add_u32 s67, s67, s68
  s_add_u32 s67, s67, 1835008
  s_lshl_b32 s71, s30, 3
  s_add_u32 s71, s71, s29
  s_lshr_b32 s69, s29, 1
  s_add_u32 s69, s69, 16
  s_bitcmp1_b32 s29, 0
  s_cselect_b32 s69, 99, s69
  s_cmp_eq_u32 s30, 2
  s_cselect_b32 s71, s69, s71
  s_cmp_eq_u32 s30, 3
  s_cselect_b32 s71, 99, s71
  s_cmp_ge_u32 s71, 10
  s_cselect_b32 s69, 1, 0
  s_mul_i32 s70, s69, 10
  s_sub_u32 s70, s71, s70
  s_lshl_b32 s68, s31, 1
  s_add_u32 s68, s68, s69
  s_mul_i32 s68, s68, 10
  s_add_u32 s68, s68, s70
  s_lshl_b32 s68, s68, 12
  s_add_u32 s68, s68, 1835008
  s_mul_i32 s69, s69, 1280
  s_mul_i32 s81, s31, 160
  s_add_u32 s69, s69, s81
  s_lshl_b32 s70, s70, 4
  s_add_u32 s70, s69, s70
  v_and_b32 v234, 7, v0
  s_add_u32 s69, s68, 4096
  s_mov_b32 s40, s4
  s_and_b32 s41, s5, 0xffff
  s_mov_b32 s42, 2560
  s_mov_b32 s43, 0x20000
  s_mov_b32 s44, s22
  s_and_b32 s45, s23, 0xffff
  s_mov_b32 s46, 2560
  s_mov_b32 s47, 0x20000
  v_lshlrev_b32 v235, 1, v234
  v_lshlrev_b32 v234, 4, v0
  buffer_load_ushort v236, v235, s[40:43], s70 offen
  s_waitcnt vmcnt(0)
  v_lshlrev_b32 v236, 16, v236
  s_mov_b32 s80, 1048576
  s_mov_b32 s62, 1069066811
  v_add_u32 v5, 0, v0
  v_mul_u32_u24 v6, 6554, v5
  v_lshrrev_b32 v6, 16, v6
  v_mul_u32_u24 v7, 10, v6
  v_sub_u32 v5, v5, v7
  v_mul_u32_u24 v6, 1280, v6
  v_lshlrev_b32 v5, 4, v5
  v_add_u32 v40, v5, v6
  v_add_u32 v5, 64, v0
  v_mul_u32_u24 v6, 6554, v5
  v_lshrrev_b32 v6, 16, v6
  v_mul_u32_u24 v7, 10, v6
  v_sub_u32 v5, v5, v7
  v_mul_u32_u24 v6, 1280, v6
  v_lshlrev_b32 v5, 4, v5
  v_add_u32 v41, v5, v6
  v_add_u32 v5, 128, v0
  v_mul_u32_u24 v6, 6554, v5
  v_lshrrev_b32 v6, 16, v6
  v_mul_u32_u24 v7, 10, v6
  v_sub_u32 v5, v5, v7
  v_mul_u32_u24 v6, 1280, v6
  v_lshlrev_b32 v5, 4, v5
  v_add_u32 v42, v5, v6
  v_add_u32 v5, 192, v0
  v_mul_u32_u24 v6, 6554, v5
  v_lshrrev_b32 v6, 16, v6
  v_mul_u32_u24 v7, 10, v6
  v_sub_u32 v5, v5, v7
  v_mul_u32_u24 v6, 1280, v6
  v_lshlrev_b32 v5, 4, v5
  v_add_u32 v43, v5, v6
  v_add_u32 v5, 256, v0
  v_mul_u32_u24 v6, 6554, v5
  v_lshrrev_b32 v6, 16, v6
  v_mul_u32_u24 v7, 10, v6
  v_sub_u32 v5, v5, v7
  v_mul_u32_u24 v6, 1280, v6
  v_lshlrev_b32 v5, 4, v5
  v_add_u32 v44, v5, v6
  s_mov_b32 s48, s12
  s_and_b32 s49, s13, 0xffff
  s_mov_b32 s50, 7864320
  s_mov_b32 s51, 0x20000
  s_mov_b32 s88, s20
  s_and_b32 s89, s21, 0xffff
  s_mov_b32 s90, 1966080
  s_mov_b32 s91, 0x20000
L_wlate:
L_ww_22:
  ds_read_b32 v5, v240 offset:4032
  s_waitcnt lgkmcnt(0)
  v_readfirstlane_b32 s56, v5
  s_cmp_ge_u32 s56, 4
  s_cbranch_scc1 L_wv_23
  s_sleep 2
  s_branch L_ww_22
L_wv_23:
  s_add_u32 s58, s38, 0
  s_cmp_lt_u32 s58, 6
  s_cbranch_scc0 L_wl_24
  s_add_u32 s58, s58, 0
  s_mul_i32 s56, s35, 245760
  s_mul_i32 s57, s31, 160
  s_add_u32 s56, s56, s57
  s_mul_i32 s57, s58, 40960
  s_add_u32 s56, s56, s57
  s_mul_i32 s57, s58, 5120
  s_add_u32 s57, s57, 56320
  s_mov_b32 m0, s57
  s_add_u32 s57, s57, 1024
  buffer_load_dwordx4 v40, s[48:51], s56 offen  lds
  s_mov_b32 m0, s57
  s_add_u32 s57, s57, 1024
  buffer_load_dwordx4 v41, s[48:51], s56 offen  lds
  s_mov_b32 m0, s57
  s_add_u32 s57, s57, 1024
  buffer_load_dwordx4 v42, s[48:51], s56 offen  lds
  s_mov_b32 m0, s57
  s_add_u32 s57, s57, 1024
  buffer_load_dwordx4 v43, s[48:51], s56 offen  lds
  s_mov_b32 m0, s57
  s_add_u32 s57, s57, 1024
  buffer_load_dwordx4 v44, s[48:51], s56 offen  lds
L_wl_24:
  s_add_u32 s58, s38, 4
  s_cmp_lt_u32 s58, 6
  s_cbranch_scc0 L_wl_25
  s_add_u32 s58, s58, 0
  s_mul_i32 s56, s35, 245760
  s_mul_i32 s57, s31, 160
  s_add_u32 s56, s56, s57
  s_mul_i32 s57, s58, 40960
  s_add_u32 s56, s56, s57
  s_mul_i32 s57, s58, 5120
  s_add_u32 s57, s57, 56320
  s_mov_b32 m0, s57
  s_add_u32 s57, s57, 1024
  buffer_load_dwordx4 v40, s[48:51], s56 offen  lds
  s_mov_b32 m0, s57
  s_add_u32 s57, s57, 1024
  buffer_load_dwordx4 v41, s[48:51], s56 offen  lds
  s_mov_b32 m0, s57
  s_add_u32 s57, s57, 1024
  buffer_load_dwordx4 v42, s[48:51], s56 offen  lds
  s_mov_b32 m0, s57
  s_add_u32 s57, s57, 1024
  buffer_load_dwordx4 v43, s[48:51], s56 offen  lds
  s_mov_b32 m0, s57
  s_add_u32 s57, s57, 1024
  buffer_load_dwordx4 v44, s[48:51], s56 offen  lds
L_wl_25:
  s_waitcnt vmcnt(0)
  s_branch L_bar3b
  s_branch L_tail
L_tail:
  s_cmp_ge_u32 s28, 2
  s_cbranch_scc1 L_bar3b
L_pw:
  ds_read_b32 v8, v240 offset:4036
  s_waitcnt lgkmcnt(0)
  v_readfirstlane_b32 s56, v8
  s_cmp_ge_u32 s56, 4
  s_cbranch_scc0 L_pw
  ds_read_b128 v[24:27], v240 offset:3968
  ds_read_b128 v[28:31], v240 offset:3984
  ds_read_b64 v[8:9], v224 offset:4096
  ds_read_b64 v[10:11], v224 offset:4864
  ds_read_b64 v[12:13], v224 offset:5632
  ds_read_b64 v[14:15], v224 offset:6400
  ds_read_b64 v[16:17], v224 offset:7168
  ds_read_b64 v[18:19], v224 offset:7936
  ds_read_b64 v[20:21], v224 offset:8704
  ds_read_b64 v[22:23], v224 offset:9472
  s_waitcnt lgkmcnt(8)
  v_max3_f32 v32, v24, v25, v26
  v_max_f32 v32, v32, v27
  v_sub_f32 v24, v24, v32
  v_sub_f32 v25, v25, v32
  v_sub_f32 v26, v26, v32
  v_sub_f32 v27, v27, v32
  v_mul_f32 v24, s62, v24
  v_mul_f32 v25, s62, v25
  v_mul_f32 v26, s62, v26
  v_mul_f32 v27, s62, v27
  v_exp_f32 v24, v24
  v_exp_f32 v25, v25
  v_exp_f32 v26, v26
  v_exp_f32 v27, v27
  s_waitcnt lgkmcnt(0)
  v_add_f32 v8, v8, v10
  v_add_f32 v9, v9, v11
  v_add_f32 v12, v12, v14
  v_add_f32 v13, v13, v15
  v_add_f32 v16, v16, v18
  v_add_f32 v17, v17, v19
  v_add_f32 v20, v20, v22
  v_add_f32 v21, v21, v23
  v_mul_f32 v33, v24, v28
  v_mul_f32 v236, v24, v8
  v_mul_f32 v237, v24, v9
  v_fmac_f32 v33, v25, v29
  v_fmac_f32 v236, v25, v12
  v_fmac_f32 v237, v25, v13
  v_fmac_f32 v33, v26, v30
  v_fmac_f32 v236, v26, v16
  v_fmac_f32 v237, v26, v17
  v_fmac_f32 v33, v27, v31
  v_fmac_f32 v236, v27, v20
  v_fmac_f32 v237, v27, v21
  v_cndmask_b32 v236, v236, v32, s[74:75]
  v_cndmask_b32 v237, v237, v33, s[74:75]
  s_mov_b64 exec, s[72:73]
  s_cmp_eq_u32 s87, 1
  s_cbranch_scc1 L_pl_26
  buffer_store_dwordx4 v[236:239], v225, s[52:55], s64 offen sc1
  s_branch L_pl_27
L_pl_26:
  buffer_store_dwordx4 v[236:239], v225, s[52:55], s64 offen
L_pl_27:
  s_mov_b64 exec, -1
  s_barrier
  ds_read_b128 v[40:43], v230 offset:0
  ds_read_b128 v[44:47], v230 offset:64
  ds_read_b64_tr_b16 v[72:73], v231 offset:30720
  ds_read_b64_tr_b16 v[74:75], v231 offset:31360
  ds_read_b64_tr_b16 v[76:77], v232 offset:35840
  ds_read_b64_tr_b16 v[78:79], v232 offset:36480
  ds_read_b64_tr_b16 v[48:49], v231 offset:0
  ds_read_b64_tr_b16 v[50:51], v231 offset:640
  ds_read_b64_tr_b16 v[52:53], v231 offset:5120
  ds_read_b64_tr_b16 v[54:55], v231 offset:5760
  ds_read_b64_tr_b16 v[56:57], v231 offset:10240
  ds_read_b64_tr_b16 v[58:59], v231 offset:10880
  ds_read_b64_tr_b16 v[60:61], v231 offset:15360
  ds_read_b64_tr_b16 v[62:63], v231 offset:16000
  ds_read_b64_tr_b16 v[64:65], v231 offset:20480
  ds_read_b64_tr_b16 v[66:67], v231 offset:21120
  ds_read_b64_tr_b16 v[68:69], v231 offset:25600
  ds_read_b64_tr_b16 v[70:71], v231 offset:26240
  v_mov_b32 v84, 0
  v_mov_b32 v85, 0
  v_mov_b32 v86, 0
  v_mov_b32 v87, 0
  v_mov_b32 v80, 0
  v_mov_b32 v81, 0
  v_mov_b32 v82, 0
  v_mov_b32 v83, 0
  s_waitcnt lgkmcnt(12)
  v_mfma_f32_16x16x32_bf16 v[84:87], v[40:43], v[72:75], v[84:87]
  v_mfma_f32_16x16x32_bf16 v[84:87], v[44:47], v[76:79], v[84:87]
  s_waitcnt lgkmcnt(0)
  s_branch L_bar4
L_gather:
L_bar3b:
  s_barrier
  buffer_load_dwordx4 v[8:11], v226, s[52:55], s65 offen sc1
  buffer_load_dwordx4 v[12:15], v226, s[52:55], s66 offen sc1
  buffer_load_dwordx4 v[16:19], v227, s[52:55], s65 offen sc1
  buffer_load_dwordx4 v[20:23], v227, s[52:55], s66 offen sc1
  s_cmp_ge_u32 s28, 5
  s_cbranch_scc1 L_o_wait
  ds_read_b128 v[40:43], v230 offset:0
  ds_read_b128 v[44:47], v230 offset:64
  ds_read_b64_tr_b16 v[72:73], v231 offset:30720
  ds_read_b64_tr_b16 v[74:75], v231 offset:31360
  ds_read_b64_tr_b16 v[76:77], v232 offset:35840
  ds_read_b64_tr_b16 v[78:79], v232 offset:36480
  ds_read_b64_tr_b16 v[48:49], v231 offset:0
  ds_read_b64_tr_b16 v[50:51], v231 offset:640
  ds_read_b64_tr_b16 v[52:53], v231 offset:5120
  ds_read_b64_tr_b16 v[54:55], v231 offset:5760
  ds_read_b64_tr_b16 v[56:57], v231 offset:10240
  ds_read_b64_tr_b16 v[58:59], v231 offset:10880
  ds_read_b64_tr_b16 v[60:61], v231 offset:15360
  ds_read_b64_tr_b16 v[62:63], v231 offset:16000
  ds_read_b64_tr_b16 v[64:65], v231 offset:20480
  ds_read_b64_tr_b16 v[66:67], v231 offset:21120
  ds_read_b64_tr_b16 v[68:69], v231 offset:25600
  ds_read_b64_tr_b16 v[70:71], v231 offset:26240
  v_mov_b32 v84, 0
  v_mov_b32 v85, 0
  v_mov_b32 v86, 0
  v_mov_b32 v87, 0
  v_mov_b32 v80, 0
  v_mov_b32 v81, 0
  v_mov_b32 v82, 0
  v_mov_b32 v83, 0
  s_waitcnt lgkmcnt(12)
  v_mfma_f32_16x16x32_bf16 v[84:87], v[40:43], v[72:75], v[84:87]
  v_mfma_f32_16x16x32_bf16 v[84:87], v[44:47], v[76:79], v[84:87]
  s_waitcnt lgkmcnt(0)
  s_branch L_o_wait
L_o_poll:
  buffer_load_dwordx4 v[8:11], v226, s[52:55], s65 offen sc1
  buffer_load_dwordx4 v[12:15], v226, s[52:55], s66 offen sc1
  buffer_load_dwordx4 v[16:19], v227, s[52:55], s65 offen sc1
  buffer_load_dwordx4 v[20:23], v227, s[52:55], s66 offen sc1
L_o_wait:
  s_waitcnt vmcnt(0)
  v_cmp_ne_u64 vcc, s[36:37], v[10:11]
  s_mov_b64 s[82:83], vcc
  v_cmp_ne_u64 vcc, s[36:37], v[14:15]
  s_or_b64 s[82:83], s[82:83], vcc
  v_cmp_ne_u64 vcc, s[36:37], v[18:19]
  s_or_b64 s[82:83], s[82:83], vcc
  v_cmp_ne_u64 vcc, s[36:37], v[22:23]
  s_or_b64 s[82:83], s[82:83], vcc
  s_cmp_eq_u64 s[82:83], 0
  s_cbranch_scc1 L_pd_28
  s_sub_u32 s80, s80, 1
  s_cmp_eq_u32 s80, 0
  s_cbranch_scc1 L_pd_28
  s_branch L_o_poll
L_pd_28:
  v_max_f32 v24, v16, v20
  v_mov_b32 v25, v24
  s_nop 1
  v_permlane32_swap_b32 v24, v25
  v_max_f32 v24, v24, v25
  v_sub_f32 v16, v16, v24
  v_sub_f32 v20, v20, v24
  v_mul_f32 v16, s62, v16
  v_mul_f32 v20, s62, v20
  v_exp_f32 v16, v16
  v_exp_f32 v20, v20
  s_nop 0
  v_mul_f32 v26, v16, v17
  v_mul_f32 v27, v16, v8
  v_mul_f32 v28, v16, v9
  v_fmac_f32 v26, v20, v21
  v_fmac_f32 v27, v20, v12
  v_fmac_f32 v28, v20, v13
  v_mov_b32 v29, v26
  v_mov_b32 v30, v27
  v_mov_b32 v31, v28
  s_nop 0
  v_permlane32_swap_b32 v26, v29
  v_permlane32_swap_b32 v27, v30
  v_permlane32_swap_b32 v28, v31
  v_add_f32 v26, v26, v29
  v_add_f32 v27, v27, v30
  v_add_f32 v28, v28, v31
  v_rcp_f32 v26, v26
  s_nop 0
  v_mul_f32 v27, v27, v26
  v_mul_f32 v28, v28, v26
  v_cvt_pk_bf16_f32 v27, v27, v28
  ds_write_b32 v228, v27
  s_waitcnt lgkmcnt(0)
L_bar4:
  s_barrier
  s_cmp_ge_u32 s28, 5
  s_cbranch_scc1 L_reduce
  ds_read_b128 v[16:19], v229 offset:0
  ds_read_b128 v[20:23], v229 offset:64
  ds_read_b128 v[24:27], v229 offset:128
  ds_read_b128 v[28:31], v229 offset:192
  ds_read_b128 v[32:35], v229 offset:256
  ds_read_b128 v[36:39], v229 offset:320
  s_waitcnt lgkmcnt(5)
  v_mfma_f32_16x16x32_bf16 v[80:83], v[16:19], v[48:51], v[80:83]
  s_waitcnt lgkmcnt(4)
  v_mfma_f32_16x16x32_bf16 v[80:83], v[20:23], v[52:55], v[80:83]
  s_waitcnt lgkmcnt(3)
  v_mfma_f32_16x16x32_bf16 v[80:83], v[24:27], v[56:59], v[80:83]
  s_waitcnt lgkmcnt(2)
  v_mfma_f32_16x16x32_bf16 v[80:83], v[28:31], v[60:63], v[80:83]
  s_waitcnt lgkmcnt(1)
  v_mfma_f32_16x16x32_bf16 v[80:83], v[32:35], v[64:67], v[80:83]
  s_waitcnt lgkmcnt(0)
  v_mfma_f32_16x16x32_bf16 v[80:83], v[36:39], v[68:71], v[80:83]
  v_cndmask_b32 v237, v84, v85, s[76:77]
  s_mov_b32 exec_hi, 0
  s_nop 5
  v_cndmask_b32 v236, v80, v81, s[76:77]
  buffer_store_dwordx4 v[236:239], v233, s[52:55], s67 offen sc1
  s_branch L_end
L_reduce:
  s_cmp_lg_u32 s28, 5
  s_cbranch_scc1 L_end
  s_cmp_ge_u32 s71, 20
  s_cbranch_scc1 L_end
L_r_poll:
  buffer_load_dwordx4 v[8:11], v234, s[52:55], s68 offen offset:0 sc1
  buffer_load_dwordx4 v[12:15], v234, s[52:55], s68 offen offset:1024 sc1
  buffer_load_dwordx4 v[16:19], v234, s[52:55], s68 offen offset:2048 sc1
  buffer_load_dwordx4 v[20:23], v234, s[52:55], s68 offen offset:3072 sc1
  s_waitcnt vmcnt(0)
  v_cmp_ne_u64 vcc, s[36:37], v[10:11]
  s_mov_b64 s[82:83], vcc
  v_cmp_ne_u64 vcc, s[36:37], v[14:15]
  s_or_b64 s[82:83], s[82:83], vcc
  v_cmp_ne_u64 vcc, s[36:37], v[18:19]
  s_or_b64 s[82:83], s[82:83], vcc
  v_cmp_ne_u64 vcc, s[36:37], v[22:23]
  s_or_b64 s[82:83], s[82:83], vcc
  s_cmp_eq_u64 s[82:83], 0
  s_cbranch_scc1 L_pd_29
  s_sub_u32 s80, s80, 1
  s_cmp_eq_u32 s80, 0
  s_cbranch_scc1 L_pd_29
  s_branch L_r_poll
L_pd_29:
  v_add_f32 v8, v8, v12
  v_add_f32 v9, v9, v13
  v_add_f32 v8, v8, v16
  v_add_f32 v9, v9, v17
  v_add_f32 v8, v8, v20
  v_add_f32 v9, v9, v21
  s_nop 0
  v_add_f32_dpp v8, v8, v8 row_ror:8 row_mask:0xf bank_mask:0xf
  v_add_f32_dpp v9, v9, v9 row_ror:8 row_mask:0xf bank_mask:0xf
  v_mov_b32 v10, v8
  v_mov_b32 v11, v9
  s_nop 0
  v_permlane16_swap_b32 v8, v10
  v_permlane16_swap_b32 v9, v11
  v_add_f32 v8, v8, v10
  v_add_f32 v9, v9, v11
  v_mov_b32 v10, v8
  v_mov_b32 v11, v9
  s_nop 0
  v_permlane32_swap_b32 v8, v10
  v_permlane32_swap_b32 v9, v11
  v_add_f32 v8, v8, v10
  v_add_f32 v9, v9, v11
  v_cvt_pk_bf16_f32 v8, v8, v9
  v_lshlrev_b32 v9, 16, v8
  v_add_f32 v9, v236, v9
  v_cvt_pk_bf16_f32 v9, v9, v9
  v_lshlrev_b32 v9, 16, v9
  v_and_b32 v8, 0xffff0000, v8
  v_add_f32 v9, v9, v8
  v_cvt_pk_bf16_f32 v9, v9, v9
  s_mov_b64 exec, 255
  buffer_store_short v9, v235, s[44:47], s70 offen
  s_cmp_lg_u32 s35, 0
  s_cbranch_scc1 L_end
  s_cmp_lg_u32 s31, 0
  s_cbranch_scc1 L_end
  s_mov_b64 exec, 1
  buffer_store_dwordx2 v[238:239], v240, s[52:55], 0 offen offset:0 sc1
L_end:
L_exit:
  s_endpgm
.section .rodata,"a"
.p2align 6
.amdhsa_kernel parallel_sum__mha_block_cached__swiglu_ffn__decode_kernel
  .amdhsa_next_free_vgpr 256
  .amdhsa_next_free_sgpr 96
  .amdhsa_accum_offset 256
  .amdhsa_group_segment_fixed_size 0
  .amdhsa_kernarg_size 96
  .amdhsa_user_sgpr_count 2
  .amdhsa_user_sgpr_kernarg_segment_ptr 1
  .amdhsa_system_sgpr_workgroup_id_x 1
  .amdhsa_float_denorm_mode_32 3
.end_amdhsa_kernel
```
